```python
import torch

def _softmax(x, axis=-1):
    return torch.softmax(x, dim=axis)
def _gelu(x):
    return torch.nn.functional.gelu(x, approximate="tanh")
def _silu(x):
    return torch.nn.functional.silu(x)
def _sigmoid(x):
    return torch.sigmoid(x)
def _layernorm(x, axis=-1, eps=1e-5):
    m = x.mean(dim=axis, keepdim=True)
    v = x.var(dim=axis, keepdim=True, unbiased=False)
    return (x - m) / torch.sqrt(v + eps)
def _scatter_add(tgt, idx, src, axis=0):
    return tgt.clone().index_add_(axis, idx, src)
def _segment_sum(src, seg, n):
    out = torch.zeros((n,) + src.shape[1:], dtype=src.dtype)
    return out.index_add_(0, seg, src)
def _pad(x, pw):
    flat = tuple(v for pair in reversed(pw) for v in pair)
    return torch.nn.functional.pad(x, flat)

kernel_name = 'parallel_sum__ssm_conv_s4__geglu_ffn__prompt'

def setup_inputs():

    _w = (lambda a: (lambda t: t.to(torch.bfloat16) if t.is_floating_point() else t)(torch.as_tensor(a)))
    def _A_setup():
        B, L, D, N = 1, 2048, 512, 128
        A_re = -(lambda _x: torch.exp(torch.as_tensor(_x)))((lambda *s: torch.randn(*s, dtype=torch.bfloat16) * 3.2)(D, N))
        A_im = torch.pi * (lambda *s: torch.randn(*s, dtype=torch.bfloat16) * 0.1)(D, N)
        B_re = (lambda *s: torch.randn(*s, dtype=torch.bfloat16) * 0.4)(D, N)
        B_im = (lambda *s: torch.randn(*s, dtype=torch.bfloat16) * 0.4)(D, N)
        C_re = (lambda *s: torch.randn(*s, dtype=torch.bfloat16) * 0.4)(D, N)
        C_im = (lambda *s: torch.randn(*s, dtype=torch.bfloat16) * 0.4)(D, N)
        log_dt = (lambda *s: torch.randn(*s, dtype=torch.bfloat16) * 0.1)(D) * 0.5 - 4.0
        Dskip = (lambda *s: torch.randn(*s, dtype=torch.bfloat16) * 0.2)(D)
        return {
            "u": _w((lambda *s: torch.randn(*s, dtype=torch.bfloat16) * 0.05)(B, L, D)),
            "A_re": _w(A_re),
            "A_im": _w(A_im),
            "B_re": _w(B_re),
            "B_im": _w(B_im),
            "C_re": _w(C_re),
            "C_im": _w(C_im),
            "log_dt": _w(log_dt),
            "Dskip": _w(Dskip),
        }
    _A_in = _A_setup()

    def _B_setup():
        B, S, D, F = 1, 2048, 512, 1376
        return {
            "x": _w((lambda *s: torch.randn(*s, dtype=torch.bfloat16) * 0.05)(B, S, D)),
            "w_gate": _w((lambda *s: torch.randn(*s, dtype=torch.bfloat16) * 0.05)(D, F)),
            "w_up": _w((lambda *s: torch.randn(*s, dtype=torch.bfloat16) * 0.05)(D, F)),
            "w_down": _w((lambda *s: torch.randn(*s, dtype=torch.bfloat16) * 0.05)(F, D)),
        }
    _B_in = _B_setup()

    return {
        "A_u": _A_in["u"],
        "A_A_re": _A_in["A_re"],
        "A_A_im": _A_in["A_im"],
        "A_B_re": _A_in["B_re"],
        "A_B_im": _A_in["B_im"],
        "A_C_re": _A_in["C_re"],
        "A_C_im": _A_in["C_im"],
        "A_log_dt": _A_in["log_dt"],
        "A_Dskip": _A_in["Dskip"],
        "B_x": _B_in["x"],
        "B_w_gate": _B_in["w_gate"],
        "B_w_up": _B_in["w_up"],
        "B_w_down": _B_in["w_down"],
    }

def reference(A_u, A_A_re, A_A_im, A_B_re, A_B_im, A_C_re, A_C_im, A_log_dt, A_Dskip, B_x, B_w_gate, B_w_up, B_w_down):
    def _A_ref(u, A_re, A_im, B_re, B_im, C_re, C_im, log_dt, Dskip):
        Bsz, L, D = u.shape
        dt = torch.exp(log_dt)[:, None]
        A = A_re + 1j * A_im
        Bc = B_re + 1j * B_im
        Cc = C_re + 1j * C_im
        logdA = dt * A
        dB = dt * Bc
        l = (lambda x, dt: x.to(dt))(torch.arange(L), A_re.dtype)
        P = torch.exp(logdA[:, :, None] * l[None, None, :])
        K = torch.einsum("dn,dnl,dn->dl", Cc, P, dB).real
        L2 = 2 * L
        Kp = _pad(K, ((0, 0), (0, L)))
        up = (lambda x, *d: x.permute(*d))(u, 0, 2, 1)
        up = _pad(up, ((0, 0), (0, 0), (0, L)))
        Kf = (lambda x, axes=(-2,-1): torch.fft.rfft2(x.float(), dim=axes))(Kp[:, None, :], axes=(-2, -1))
        Uf = (lambda x, axes=(-2,-1): torch.fft.rfft2(x.float(), dim=axes))(up[:, :, None, :], axes=(-2, -1))
        Yf = Uf * Kf[None, :, :, :]
        y = (lambda x, s, axes=(-2,-1): torch.fft.irfft2(x, s=s, dim=axes).to(torch.bfloat16))(Yf, (1, L2), axes=(-2, -1))[:, :, 0, :L]
        y = (lambda x, *d: x.permute(*d))(y, 0, 2, 1) + u * Dskip[None, None, :]
        return y

    def _B_ref(x, w_gate, w_up, w_down):
        return (_gelu(x @ w_gate) * (x @ w_up)) @ w_down

    x = A_u
    xn = _layernorm(x, axis=-1)
    return x + _A_ref(xn, A_A_re, A_A_im, A_B_re, A_B_im, A_C_re, A_C_im, A_log_dt, A_Dskip) + _B_ref(xn, B_w_gate, B_w_up, B_w_down)
```

```asm
; @launch grid=(256,1,1) block=(768,1,1) lds=158656
.amdgcn_target "amdgcn-amd-amdhsa--gfx950"
.text
.globl parallel_sum__ssm_conv_s4__geglu_ffn__prompt_kernel
.p2align 8
.type parallel_sum__ssm_conv_s4__geglu_ffn__prompt_kernel,@function
parallel_sum__ssm_conv_s4__geglu_ffn__prompt_kernel:
    s_cmp_ge_u32 s2, 256
    s_cbranch_scc1 L_endF_2
    s_load_dwordx16 s[36:51], s[0:1], 0
    s_load_dwordx16 s[52:67], s[0:1], 64
    s_getpc_b64 s[74:75]
L_pc0_3:
    s_add_u32 s74, s74, parallel_sum__ssm_conv_s4__geglu_ffn__prompt_kernel-L_pc0_3
    s_addc_u32 s75, s75, -1
    s_lshr_b32 s76, s2, 3
    s_and_b32 s76, s76, 3
    s_mul_i32 s76, s76, 96
    v_lshrrev_b32 v1, 6, v0
    v_lshlrev_b32 v1, 3, v1
    v_and_b32 v2, 7, v0
    v_add_u32 v1, v1, v2
    v_add_u32 v1, s76, v1
    v_lshlrev_b32 v1, 6, v1
    v_and_b32 v2, 63, v0
    v_cmp_gt_u32 vcc, 8, v2
    s_and_saveexec_b64 s[76:77], vcc
    global_load_dword v166, v1, s[74:75]
    s_mov_b64 exec, s[76:77]
    v_lshrrev_b32 v1, 6, v0
    v_and_b32 v0, 63, v0
    s_and_b32 s7, s2, 7
    v_readfirstlane_b32 s3, v1
    s_lshr_b32 s24, s2, 3
    s_and_b32 s25, s7, 1
    s_lshl_b32 s25, s25, 3
    s_and_b32 s26, s24, 7
    s_add_u32 s4, s25, s26
    s_lshr_b32 s25, s7, 1
    s_lshl_b32 s25, s25, 2
    s_lshr_b32 s26, s24, 3
    s_add_u32 s5, s25, s26
    s_lshl_b32 s25, s5, 1
    s_add_u32 s25, s25, s4
    s_and_b32 s6, s25, 7
    s_cmp_lt_u32 s3, 4
    s_cbranch_scc1 L_g_4
    s_cmp_lt_u32 s3, 8
    s_cbranch_scc1 L_ld_5
    s_lshr_b32 s7, s5, 3
    s_add_u32 s7, s7, s6
    s_and_b32 s7, s7, 7
    s_lshl_b32 s7, s7, 1
    s_bfe_u32 s33, s5, 0x10002
    s_add_u32 s87, s7, s33
    s_setprio 3
    s_sub_u32 s68, s3, 8
    s_lshr_b32 s7, s68, 1
    s_lshl_b32 s32, s2, 1
    s_add_u32 s32, s32, s7
    s_and_b32 s7, s68, 1
    s_lshl_b32 s7, s7, 7
    s_lshl_b32 s33, s32, 8
    s_add_u32 s33, s33, s7
    v_lshlrev_b32 v1, 1, v0
    v_add_u32 v1, s33, v1
    s_lshl_b32 s34, s32, 1
    v_mov_b32 v2, s34
    s_lshl_b32 s69, s68, 13
    s_add_u32 s69, s69, 122880
    s_waitcnt lgkmcnt(0)
    global_load_ushort v8, v1, s[38:39]
    global_load_ushort v9, v1, s[40:41]
    global_load_ushort v10, v1, s[42:43]
    global_load_ushort v11, v1, s[44:45]
    global_load_ushort v12, v1, s[46:47]
    global_load_ushort v13, v1, s[48:49]
    global_load_ushort v14, v2, s[50:51]
    global_load_ushort v151, v2, s[52:53]
    s_or_b32 s7, s2, s68
    s_cmp_lg_u32 s7, 0
    s_cbranch_scc1 L_nononce_8
    s_memrealtime s[70:71]
    v_mov_b32 v2, 0
    s_waitcnt lgkmcnt(0)
    s_or_b32 s70, s70, 1
    v_mov_b32 v4, s70
    v_mov_b32 v5, s71
    s_mov_b64 exec, 1
    global_store_dwordx2 v2, v[4:5], s[64:65] sc1
    v_mov_b32 v2, 19398656
    global_store_dwordx2 v2, v[4:5], s[66:67]
    s_mov_b64 exec, -1
L_nononce_8:
    s_lshr_b32 s77, s5, 3
    v_and_b32 v1, 15, v0
    v_lshrrev_b32 v2, 2, v1
    v_and_b32 v1, 3, v1
    v_lshrrev_b32 v3, 4, v0
    s_bfe_u32 s7, s5, 0x10002
    s_lshl_b32 s7, s7, 1
    s_and_b32 s33, s68, 1
    s_add_u32 s7, s7, s33
    s_lshl_b32 s7, s7, 1
    v_lshrrev_b32 v6, 1, v1
    v_add_u32 v5, s7, v6
    v_and_b32 v6, 1, v3
    v_lshlrev_b32 v6, 2, v6
    v_lshrrev_b32 v7, 1, v2
    v_add_u32 v6, v6, v7
    v_lshlrev_b32 v7, 3, v3
    v_add_u32 v7, v7, v2
    s_lshr_b32 s7, s68, 1
    s_lshl_b32 s7, s7, 6
    v_add_u32 v7, s7, v7
    v_lshlrev_b32 v7, 7, v7
    v_and_b32 v1, 1, v1
    v_lshlrev_b32 v1, 3, v1
    v_add_u32 v7, v7, v1
    v_xor_b32 v1, v5, v6
    v_lshlrev_b32 v1, 4, v1
    v_add_u32 v162, v7, v1
    v_add_u32 v6, 2, v6
    v_xor_b32 v1, v5, v6
    v_lshlrev_b32 v1, 4, v1
    v_add_u32 v163, v7, v1
    v_mov_b32 v150, 0
    v_lshrrev_b32 v3, 4, v0
    v_lshrrev_b32 v4, 2, v0
    v_and_b32 v4, 3, v4
    v_and_b32 v5, 3, v0
    v_lshlrev_b32 v6, 10, v3
    v_lshlrev_b32 v5, 2, v5
    v_add_u32 v6, v6, v5
    v_add_u32 v6, s69, v6
    v_xor_b32 v5, 0, v4
    v_lshlrev_b32 v5, 4, v5
    v_add_u32 v44, v6, v5
    v_add_u32 v144, 4096, v44
    v_xor_b32 v5, 3, v4
    v_lshlrev_b32 v5, 4, v5
    v_add_u32 v45, v6, v5
    v_add_u32 v145, 4096, v45
    v_xor_b32 v5, 2, v4
    v_lshlrev_b32 v5, 4, v5
    v_add_u32 v46, v6, v5
    v_add_u32 v146, 4096, v46
    v_xor_b32 v5, 1, v4
    v_lshlrev_b32 v5, 4, v5
    v_add_u32 v47, v6, v5
    v_add_u32 v147, 4096, v47
    v_and_b32 v4, 15, v0
    v_mov_b32 v5, v4
    v_lshrrev_b32 v6, 2, v5
    v_sub_u32 v6, 4, v6
    v_and_b32 v6, 3, v6
    v_xor_b32 v6, v6, v3
    v_lshlrev_b32 v6, 4, v6
    v_lshlrev_b32 v5, 6, v5
    v_add_u32 v5, v5, v6
    v_add_u32 v48, s69, v5
    v_lshrrev_b32 v5, 1, v4
    v_and_b32 v5, 1, v5
    v_add_u32 v5, v5, v4
    v_lshrrev_b32 v5, 1, v5
    v_lshrrev_b32 v6, 2, v5
    v_sub_u32 v6, 4, v6
    v_and_b32 v6, 3, v6
    v_xor_b32 v6, v6, v3
    v_lshlrev_b32 v6, 4, v6
    v_lshlrev_b32 v5, 6, v5
    v_add_u32 v5, v5, v6
    v_add_u32 v49, s69, v5
    v_lshrrev_b32 v5, 2, v4
    v_and_b32 v5, 1, v5
    v_add_u32 v5, v5, v4
    v_add_u32 v5, 1, v5
    v_lshrrev_b32 v5, 2, v5
    v_add_u32 v5, 9, v5
    v_lshrrev_b32 v6, 2, v5
    v_sub_u32 v6, 4, v6
    v_and_b32 v6, 3, v6
    v_xor_b32 v6, v6, v3
    v_lshlrev_b32 v6, 4, v6
    v_lshlrev_b32 v5, 6, v5
    v_add_u32 v5, v5, v6
    v_add_u32 v50, s69, v5
    v_lshrrev_b32 v5, 2, v4
    v_and_b32 v5, 1, v5
    v_add_u32 v5, v5, v4
    v_add_u32 v5, 1, v5
    v_lshrrev_b32 v5, 2, v5
    v_lshrrev_b32 v6, 2, v5
    v_sub_u32 v6, 4, v6
    v_and_b32 v6, 3, v6
    v_xor_b32 v6, v6, v3
    v_lshlrev_b32 v6, 4, v6
    v_lshlrev_b32 v5, 6, v5
    v_add_u32 v5, v5, v6
    v_add_u32 v51, s69, v5
    v_lshrrev_b32 v5, 3, v4
    v_and_b32 v5, 1, v5
    v_add_u32 v5, v5, v4
    v_add_u32 v5, 3, v5
    v_lshrrev_b32 v5, 3, v5
    v_add_u32 v5, 5, v5
    v_lshrrev_b32 v6, 2, v5
    v_sub_u32 v6, 4, v6
    v_and_b32 v6, 3, v6
    v_xor_b32 v6, v6, v3
    v_lshlrev_b32 v6, 4, v6
    v_lshlrev_b32 v5, 6, v5
    v_add_u32 v5, v5, v6
    v_add_u32 v52, s69, v5
    v_lshrrev_b32 v5, 3, v4
    v_and_b32 v5, 1, v5
    v_add_u32 v5, v5, v4
    v_add_u32 v5, 3, v5
    v_lshrrev_b32 v5, 3, v5
    v_add_u32 v5, 8, v5
    v_lshrrev_b32 v6, 2, v5
    v_sub_u32 v6, 4, v6
    v_and_b32 v6, 3, v6
    v_xor_b32 v6, v6, v3
    v_lshlrev_b32 v6, 4, v6
    v_lshlrev_b32 v5, 6, v5
    v_add_u32 v5, v5, v6
    v_add_u32 v53, s69, v5
    v_lshrrev_b32 v5, 3, v4
    v_and_b32 v5, 1, v5
    v_add_u32 v5, v5, v4
    v_add_u32 v5, 3, v5
    v_lshrrev_b32 v5, 3, v5
    v_add_u32 v5, 11, v5
    v_lshrrev_b32 v6, 2, v5
    v_sub_u32 v6, 4, v6
    v_and_b32 v6, 3, v6
    v_xor_b32 v6, v6, v3
    v_lshlrev_b32 v6, 4, v6
    v_lshlrev_b32 v5, 6, v5
    v_add_u32 v5, v5, v6
    v_add_u32 v54, s69, v5
    v_lshrrev_b32 v5, 3, v4
    v_and_b32 v5, 1, v5
    v_add_u32 v5, v5, v4
    v_add_u32 v5, 3, v5
    v_lshrrev_b32 v5, 3, v5
    v_lshrrev_b32 v6, 2, v5
    v_sub_u32 v6, 4, v6
    v_and_b32 v6, 3, v6
    v_xor_b32 v6, v6, v3
    v_lshlrev_b32 v6, 4, v6
    v_lshlrev_b32 v5, 6, v5
    v_add_u32 v5, v5, v6
    v_add_u32 v55, s69, v5
    v_mov_b32 v80, 0
    v_mov_b32 v81, 0
    v_mov_b32 v82, 0
    v_mov_b32 v83, 0
    v_mov_b32 v84, 0
    v_mov_b32 v85, 0
    v_mov_b32 v86, 0
    v_mov_b32 v87, 0
    v_mov_b32 v88, 0
    v_mov_b32 v89, 0
    v_mov_b32 v90, 0
    v_mov_b32 v91, 0
    v_mov_b32 v92, 0
    v_mov_b32 v93, 0
    v_mov_b32 v94, 0
    v_mov_b32 v95, 0
    v_mov_b32 v96, 0
    v_mov_b32 v97, 0
    v_mov_b32 v98, 0
    v_mov_b32 v99, 0
    v_mov_b32 v100, 0
    v_mov_b32 v101, 0
    v_mov_b32 v102, 0
    v_mov_b32 v103, 0
    v_mov_b32 v104, 0
    v_mov_b32 v105, 0
    v_mov_b32 v106, 0
    v_mov_b32 v107, 0
    v_mov_b32 v108, 0
    v_mov_b32 v109, 0
    v_mov_b32 v110, 0
    v_mov_b32 v111, 0
    s_waitcnt vmcnt(0)
    v_lshlrev_b32 v8, 16, v8
    v_lshlrev_b32 v9, 16, v9
    v_lshlrev_b32 v10, 16, v10
    v_lshlrev_b32 v11, 16, v11
    v_lshlrev_b32 v12, 16, v12
    v_lshlrev_b32 v13, 16, v13
    v_lshlrev_b32 v14, 16, v14
    v_mul_f32 v14, 0x3fb8aa3b, v14
    v_exp_f32 v14, v14
    s_nop 0
    v_cvt_pk_bf16_f32 v14, v14, v14
    v_and_b32 v14, 0xffff0000, v14
    v_mul_f32 v8, v14, v8
    v_mul_f32 v9, v14, v9
    v_mul_f32 v10, v14, v10
    v_mul_f32 v11, v14, v11
    v_mul_f32 v16, 0x3fb8aa3b, v8
    v_mul_f32 v17, 0x3e22f983, v9
    v_mul_f32 v18, v12, v10
    v_mul_f32 v19, v12, v11
    v_fma_f32 v18, -v13, v11, v18
    v_fma_f32 v19, v13, v10, v19
    v_mul_f32 v1, 0x3f800000, v16
    v_mul_f32 v2, 0x3f800000, v17
    v_exp_f32 v1, v1
    v_fract_f32 v2, v2
    v_cos_f32 v5, v2
    v_sin_f32 v6, v2
    s_nop 0
    v_mul_f32 v20, v1, v5
    v_mul_f32 v21, v1, v6
    v_mul_f32 v1, 0x41800000, v16
    v_mul_f32 v2, 0x41800000, v17
    v_exp_f32 v1, v1
    v_fract_f32 v2, v2
    v_cos_f32 v5, v2
    v_sin_f32 v6, v2
    s_nop 0
    v_mul_f32 v28, v1, v5
    v_mul_f32 v29, v1, v6
    v_mul_f32 v1, 0x43800000, v16
    v_mul_f32 v2, 0x43800000, v17
    v_exp_f32 v1, v1
    v_fract_f32 v2, v2
    v_cos_f32 v5, v2
    v_sin_f32 v6, v2
    s_nop 0
    v_mul_f32 v30, v1, v5
    v_mul_f32 v31, v1, v6
    v_pk_mul_f32 v[36:37], v[20:21], v[20:21] op_sel:[0,0] op_sel_hi:[0,1]
    v_pk_fma_f32 v[22:23], v[20:21], v[20:21], v[36:37] op_sel:[1,1,0] op_sel_hi:[1,0,1] neg_lo:[1,0,0]
    v_pk_mul_f32 v[36:37], v[22:23], v[22:23] op_sel:[0,0] op_sel_hi:[0,1]
    v_pk_fma_f32 v[24:25], v[22:23], v[22:23], v[36:37] op_sel:[1,1,0] op_sel_hi:[1,0,1] neg_lo:[1,0,0]
    v_pk_mul_f32 v[36:37], v[24:25], v[24:25] op_sel:[0,0] op_sel_hi:[0,1]
    v_pk_fma_f32 v[26:27], v[24:25], v[24:25], v[36:37] op_sel:[1,1,0] op_sel_hi:[1,0,1] neg_lo:[1,0,0]
    v_mov_b32 v32, 1.0
    v_mov_b32 v33, 0
    v_mov_b32 v34, v18
    v_mov_b32 v35, v19
    v_cvt_pk_bf16_f32 v112, v32, -v33
    v_cvt_pk_bf16_f32 v113, v34, v35
    v_pk_mul_f32 v[36:37], v[32:33], v[28:29] op_sel:[0,0] op_sel_hi:[0,1]
    v_pk_mul_f32 v[38:39], v[34:35], v[20:21] op_sel:[0,0] op_sel_hi:[0,1]
    v_pk_fma_f32 v[32:33], v[32:33], v[28:29], v[36:37] op_sel:[1,1,0] op_sel_hi:[1,0,1] neg_lo:[1,0,0]
    v_pk_fma_f32 v[34:35], v[34:35], v[20:21], v[38:39] op_sel:[1,1,0] op_sel_hi:[1,0,1] neg_lo:[1,0,0]
    v_cvt_pk_bf16_f32 v114, v32, -v33
    ds_write2_b32 v44, v112, v114 offset0:0 offset1:16
    v_cvt_pk_bf16_f32 v115, v34, v35
    ds_write2_b32 v144, v113, v115 offset0:0 offset1:16
    v_pk_mul_f32 v[36:37], v[32:33], v[28:29] op_sel:[0,0] op_sel_hi:[0,1]
    v_pk_mul_f32 v[38:39], v[34:35], v[20:21] op_sel:[0,0] op_sel_hi:[0,1]
    v_pk_fma_f32 v[32:33], v[32:33], v[28:29], v[36:37] op_sel:[1,1,0] op_sel_hi:[1,0,1] neg_lo:[1,0,0]
    v_pk_fma_f32 v[34:35], v[34:35], v[20:21], v[38:39] op_sel:[1,1,0] op_sel_hi:[1,0,1] neg_lo:[1,0,0]
    v_cvt_pk_bf16_f32 v116, v32, -v33
    v_cvt_pk_bf16_f32 v117, v34, v35
    v_pk_mul_f32 v[36:37], v[32:33], v[28:29] op_sel:[0,0] op_sel_hi:[0,1]
    v_pk_mul_f32 v[38:39], v[34:35], v[20:21] op_sel:[0,0] op_sel_hi:[0,1]
    v_pk_fma_f32 v[32:33], v[32:33], v[28:29], v[36:37] op_sel:[1,1,0] op_sel_hi:[1,0,1] neg_lo:[1,0,0]
    v_pk_fma_f32 v[34:35], v[34:35], v[20:21], v[38:39] op_sel:[1,1,0] op_sel_hi:[1,0,1] neg_lo:[1,0,0]
    v_cvt_pk_bf16_f32 v118, v32, -v33
    ds_write2_b32 v44, v116, v118 offset0:32 offset1:48
    v_cvt_pk_bf16_f32 v119, v34, v35
    ds_write2_b32 v144, v117, v119 offset0:32 offset1:48
    v_pk_mul_f32 v[36:37], v[32:33], v[28:29] op_sel:[0,0] op_sel_hi:[0,1]
    v_pk_mul_f32 v[38:39], v[34:35], v[20:21] op_sel:[0,0] op_sel_hi:[0,1]
    v_pk_fma_f32 v[32:33], v[32:33], v[28:29], v[36:37] op_sel:[1,1,0] op_sel_hi:[1,0,1] neg_lo:[1,0,0]
    v_pk_fma_f32 v[34:35], v[34:35], v[20:21], v[38:39] op_sel:[1,1,0] op_sel_hi:[1,0,1] neg_lo:[1,0,0]
    v_cvt_pk_bf16_f32 v112, v32, -v33
    v_cvt_pk_bf16_f32 v113, v34, v35
    v_pk_mul_f32 v[36:37], v[32:33], v[28:29] op_sel:[0,0] op_sel_hi:[0,1]
    v_pk_mul_f32 v[38:39], v[34:35], v[20:21] op_sel:[0,0] op_sel_hi:[0,1]
    v_pk_fma_f32 v[32:33], v[32:33], v[28:29], v[36:37] op_sel:[1,1,0] op_sel_hi:[1,0,1] neg_lo:[1,0,0]
    v_pk_fma_f32 v[34:35], v[34:35], v[20:21], v[38:39] op_sel:[1,1,0] op_sel_hi:[1,0,1] neg_lo:[1,0,0]
    v_cvt_pk_bf16_f32 v114, v32, -v33
    ds_write2_b32 v45, v112, v114 offset0:64 offset1:80
    v_cvt_pk_bf16_f32 v115, v34, v35
    ds_write2_b32 v145, v113, v115 offset0:64 offset1:80
    v_pk_mul_f32 v[36:37], v[32:33], v[28:29] op_sel:[0,0] op_sel_hi:[0,1]
    v_pk_mul_f32 v[38:39], v[34:35], v[20:21] op_sel:[0,0] op_sel_hi:[0,1]
    v_pk_fma_f32 v[32:33], v[32:33], v[28:29], v[36:37] op_sel:[1,1,0] op_sel_hi:[1,0,1] neg_lo:[1,0,0]
    v_pk_fma_f32 v[34:35], v[34:35], v[20:21], v[38:39] op_sel:[1,1,0] op_sel_hi:[1,0,1] neg_lo:[1,0,0]
    v_cvt_pk_bf16_f32 v116, v32, -v33
    v_cvt_pk_bf16_f32 v117, v34, v35
    v_pk_mul_f32 v[36:37], v[32:33], v[28:29] op_sel:[0,0] op_sel_hi:[0,1]
    v_pk_mul_f32 v[38:39], v[34:35], v[20:21] op_sel:[0,0] op_sel_hi:[0,1]
    v_pk_fma_f32 v[32:33], v[32:33], v[28:29], v[36:37] op_sel:[1,1,0] op_sel_hi:[1,0,1] neg_lo:[1,0,0]
    v_pk_fma_f32 v[34:35], v[34:35], v[20:21], v[38:39] op_sel:[1,1,0] op_sel_hi:[1,0,1] neg_lo:[1,0,0]
    v_cvt_pk_bf16_f32 v118, v32, -v33
    ds_write2_b32 v45, v116, v118 offset0:96 offset1:112
    v_cvt_pk_bf16_f32 v119, v34, v35
    ds_write2_b32 v145, v117, v119 offset0:96 offset1:112
    v_pk_mul_f32 v[36:37], v[32:33], v[28:29] op_sel:[0,0] op_sel_hi:[0,1]
    v_pk_mul_f32 v[38:39], v[34:35], v[20:21] op_sel:[0,0] op_sel_hi:[0,1]
    v_pk_fma_f32 v[32:33], v[32:33], v[28:29], v[36:37] op_sel:[1,1,0] op_sel_hi:[1,0,1] neg_lo:[1,0,0]
    v_pk_fma_f32 v[34:35], v[34:35], v[20:21], v[38:39] op_sel:[1,1,0] op_sel_hi:[1,0,1] neg_lo:[1,0,0]
    v_cvt_pk_bf16_f32 v112, v32, -v33
    v_cvt_pk_bf16_f32 v113, v34, v35
    v_pk_mul_f32 v[36:37], v[32:33], v[28:29] op_sel:[0,0] op_sel_hi:[0,1]
    v_pk_mul_f32 v[38:39], v[34:35], v[20:21] op_sel:[0,0] op_sel_hi:[0,1]
    v_pk_fma_f32 v[32:33], v[32:33], v[28:29], v[36:37] op_sel:[1,1,0] op_sel_hi:[1,0,1] neg_lo:[1,0,0]
    v_pk_fma_f32 v[34:35], v[34:35], v[20:21], v[38:39] op_sel:[1,1,0] op_sel_hi:[1,0,1] neg_lo:[1,0,0]
    v_cvt_pk_bf16_f32 v114, v32, -v33
    ds_write2_b32 v46, v112, v114 offset0:128 offset1:144
    v_cvt_pk_bf16_f32 v115, v34, v35
    ds_write2_b32 v146, v113, v115 offset0:128 offset1:144
    v_pk_mul_f32 v[36:37], v[32:33], v[28:29] op_sel:[0,0] op_sel_hi:[0,1]
    v_pk_mul_f32 v[38:39], v[34:35], v[20:21] op_sel:[0,0] op_sel_hi:[0,1]
    v_pk_fma_f32 v[32:33], v[32:33], v[28:29], v[36:37] op_sel:[1,1,0] op_sel_hi:[1,0,1] neg_lo:[1,0,0]
    v_pk_fma_f32 v[34:35], v[34:35], v[20:21], v[38:39] op_sel:[1,1,0] op_sel_hi:[1,0,1] neg_lo:[1,0,0]
    v_cvt_pk_bf16_f32 v116, v32, -v33
    v_cvt_pk_bf16_f32 v117, v34, v35
    v_pk_mul_f32 v[36:37], v[32:33], v[28:29] op_sel:[0,0] op_sel_hi:[0,1]
    v_pk_mul_f32 v[38:39], v[34:35], v[20:21] op_sel:[0,0] op_sel_hi:[0,1]
    v_pk_fma_f32 v[32:33], v[32:33], v[28:29], v[36:37] op_sel:[1,1,0] op_sel_hi:[1,0,1] neg_lo:[1,0,0]
    v_pk_fma_f32 v[34:35], v[34:35], v[20:21], v[38:39] op_sel:[1,1,0] op_sel_hi:[1,0,1] neg_lo:[1,0,0]
    v_cvt_pk_bf16_f32 v118, v32, -v33
    ds_write2_b32 v46, v116, v118 offset0:160 offset1:176
    v_cvt_pk_bf16_f32 v119, v34, v35
    ds_write2_b32 v146, v117, v119 offset0:160 offset1:176
    v_pk_mul_f32 v[36:37], v[32:33], v[28:29] op_sel:[0,0] op_sel_hi:[0,1]
    v_pk_mul_f32 v[38:39], v[34:35], v[20:21] op_sel:[0,0] op_sel_hi:[0,1]
    v_pk_fma_f32 v[32:33], v[32:33], v[28:29], v[36:37] op_sel:[1,1,0] op_sel_hi:[1,0,1] neg_lo:[1,0,0]
    v_pk_fma_f32 v[34:35], v[34:35], v[20:21], v[38:39] op_sel:[1,1,0] op_sel_hi:[1,0,1] neg_lo:[1,0,0]
    v_cvt_pk_bf16_f32 v112, v32, -v33
    v_cvt_pk_bf16_f32 v113, v34, v35
    v_pk_mul_f32 v[36:37], v[32:33], v[28:29] op_sel:[0,0] op_sel_hi:[0,1]
    v_pk_mul_f32 v[38:39], v[34:35], v[20:21] op_sel:[0,0] op_sel_hi:[0,1]
    v_pk_fma_f32 v[32:33], v[32:33], v[28:29], v[36:37] op_sel:[1,1,0] op_sel_hi:[1,0,1] neg_lo:[1,0,0]
    v_pk_fma_f32 v[34:35], v[34:35], v[20:21], v[38:39] op_sel:[1,1,0] op_sel_hi:[1,0,1] neg_lo:[1,0,0]
    v_cvt_pk_bf16_f32 v114, v32, -v33
    ds_write2_b32 v47, v112, v114 offset0:192 offset1:208
    v_cvt_pk_bf16_f32 v115, v34, v35
    ds_write2_b32 v147, v113, v115 offset0:192 offset1:208
    v_pk_mul_f32 v[36:37], v[32:33], v[28:29] op_sel:[0,0] op_sel_hi:[0,1]
    v_pk_mul_f32 v[38:39], v[34:35], v[20:21] op_sel:[0,0] op_sel_hi:[0,1]
    v_pk_fma_f32 v[32:33], v[32:33], v[28:29], v[36:37] op_sel:[1,1,0] op_sel_hi:[1,0,1] neg_lo:[1,0,0]
    v_pk_fma_f32 v[34:35], v[34:35], v[20:21], v[38:39] op_sel:[1,1,0] op_sel_hi:[1,0,1] neg_lo:[1,0,0]
    v_cvt_pk_bf16_f32 v116, v32, -v33
    v_cvt_pk_bf16_f32 v117, v34, v35
    v_pk_mul_f32 v[36:37], v[32:33], v[28:29] op_sel:[0,0] op_sel_hi:[0,1]
    v_pk_mul_f32 v[38:39], v[34:35], v[20:21] op_sel:[0,0] op_sel_hi:[0,1]
    v_pk_fma_f32 v[32:33], v[32:33], v[28:29], v[36:37] op_sel:[1,1,0] op_sel_hi:[1,0,1] neg_lo:[1,0,0]
    v_pk_fma_f32 v[34:35], v[34:35], v[20:21], v[38:39] op_sel:[1,1,0] op_sel_hi:[1,0,1] neg_lo:[1,0,0]
    v_cvt_pk_bf16_f32 v118, v32, -v33
    ds_write2_b32 v47, v116, v118 offset0:224 offset1:240
    v_cvt_pk_bf16_f32 v119, v34, v35
    ds_write2_b32 v147, v117, v119 offset0:224 offset1:240
    ds_read_b128 v[56:59], v48 offset:0
    ds_read_b128 v[60:63], v48 offset:1024
    ds_read_b128 v[64:67], v48 offset:2048
    ds_read_b128 v[68:71], v48 offset:3072
    v_pk_mul_f32 v[36:37], v[18:19], v[30:31] op_sel:[0,0] op_sel_hi:[0,1]
    v_pk_fma_f32 v[40:41], v[18:19], v[30:31], v[36:37] op_sel:[1,1,0] op_sel_hi:[1,0,1] neg_lo:[1,0,0]
    v_pk_mul_f32 v[36:37], v[40:41], v[30:31] op_sel:[0,0] op_sel_hi:[0,1]
    v_pk_fma_f32 v[42:43], v[40:41], v[30:31], v[36:37] op_sel:[1,1,0] op_sel_hi:[1,0,1] neg_lo:[1,0,0]
    v_mov_b32 v32, v40
    v_mov_b32 v33, v41
    v_mov_b32 v34, v42
    v_mov_b32 v35, v43
    v_cvt_pk_bf16_f32 v112, v32, v33
    v_cvt_pk_bf16_f32 v113, v34, v35
    ds_write_b32 v46, v113 offset:576
    v_pk_mul_f32 v[36:37], v[32:33], v[22:23] op_sel:[0,0] op_sel_hi:[0,1]
    v_pk_mul_f32 v[38:39], v[34:35], v[24:25] op_sel:[0,0] op_sel_hi:[0,1]
    v_pk_fma_f32 v[32:33], v[32:33], v[22:23], v[36:37] op_sel:[1,1,0] op_sel_hi:[1,0,1] neg_lo:[1,0,0]
    v_pk_fma_f32 v[34:35], v[34:35], v[24:25], v[38:39] op_sel:[1,1,0] op_sel_hi:[1,0,1] neg_lo:[1,0,0]
    v_cvt_pk_bf16_f32 v114, v32, v33
    ds_write2_b32 v44, v112, v114 offset0:0 offset1:16
    v_cvt_pk_bf16_f32 v115, v34, v35
    v_pk_mul_f32 v[36:37], v[32:33], v[22:23] op_sel:[0,0] op_sel_hi:[0,1]
    v_pk_mul_f32 v[38:39], v[34:35], v[24:25] op_sel:[0,0] op_sel_hi:[0,1]
    v_pk_fma_f32 v[32:33], v[32:33], v[22:23], v[36:37] op_sel:[1,1,0] op_sel_hi:[1,0,1] neg_lo:[1,0,0]
    v_pk_fma_f32 v[34:35], v[34:35], v[24:25], v[38:39] op_sel:[1,1,0] op_sel_hi:[1,0,1] neg_lo:[1,0,0]
    v_cvt_pk_bf16_f32 v116, v32, v33
    v_cvt_pk_bf16_f32 v117, v34, v35
    ds_write2_b32 v46, v115, v117 offset0:160 offset1:176
    v_pk_mul_f32 v[36:37], v[32:33], v[22:23] op_sel:[0,0] op_sel_hi:[0,1]
    v_pk_mul_f32 v[38:39], v[34:35], v[24:25] op_sel:[0,0] op_sel_hi:[0,1]
    v_pk_fma_f32 v[32:33], v[32:33], v[22:23], v[36:37] op_sel:[1,1,0] op_sel_hi:[1,0,1] neg_lo:[1,0,0]
    v_pk_fma_f32 v[34:35], v[34:35], v[24:25], v[38:39] op_sel:[1,1,0] op_sel_hi:[1,0,1] neg_lo:[1,0,0]
    v_cvt_pk_bf16_f32 v118, v32, v33
    ds_write2_b32 v44, v116, v118 offset0:32 offset1:48
    v_cvt_pk_bf16_f32 v119, v34, v35
    v_pk_mul_f32 v[36:37], v[32:33], v[22:23] op_sel:[0,0] op_sel_hi:[0,1]
    v_pk_mul_f32 v[38:39], v[34:35], v[24:25] op_sel:[0,0] op_sel_hi:[0,1]
    v_pk_fma_f32 v[32:33], v[32:33], v[22:23], v[36:37] op_sel:[1,1,0] op_sel_hi:[1,0,1] neg_lo:[1,0,0]
    v_pk_fma_f32 v[34:35], v[34:35], v[24:25], v[38:39] op_sel:[1,1,0] op_sel_hi:[1,0,1] neg_lo:[1,0,0]
    v_cvt_pk_bf16_f32 v112, v32, v33
    v_cvt_pk_bf16_f32 v113, v34, v35
    ds_write2_b32 v47, v119, v113 offset0:192 offset1:208
    v_pk_mul_f32 v[36:37], v[32:33], v[22:23] op_sel:[0,0] op_sel_hi:[0,1]
    v_pk_fma_f32 v[32:33], v[32:33], v[22:23], v[36:37] op_sel:[1,1,0] op_sel_hi:[1,0,1] neg_lo:[1,0,0]
    v_cvt_pk_bf16_f32 v114, v32, v33
    ds_write2_b32 v45, v112, v114 offset0:64 offset1:80
    v_pk_mul_f32 v[36:37], v[32:33], v[22:23] op_sel:[0,0] op_sel_hi:[0,1]
    v_pk_fma_f32 v[32:33], v[32:33], v[22:23], v[36:37] op_sel:[1,1,0] op_sel_hi:[1,0,1] neg_lo:[1,0,0]
    v_cvt_pk_bf16_f32 v115, v32, v33
    v_pk_mul_f32 v[36:37], v[32:33], v[22:23] op_sel:[0,0] op_sel_hi:[0,1]
    v_pk_fma_f32 v[32:33], v[32:33], v[22:23], v[36:37] op_sel:[1,1,0] op_sel_hi:[1,0,1] neg_lo:[1,0,0]
    v_cvt_pk_bf16_f32 v116, v32, v33
    ds_write2_b32 v45, v115, v116 offset0:96 offset1:112
    v_pk_mul_f32 v[36:37], v[32:33], v[22:23] op_sel:[0,0] op_sel_hi:[0,1]
    v_pk_fma_f32 v[32:33], v[32:33], v[22:23], v[36:37] op_sel:[1,1,0] op_sel_hi:[1,0,1] neg_lo:[1,0,0]
    v_cvt_pk_bf16_f32 v117, v32, v33
    ds_write_b32 v46, v117 offset:512
    ds_read_b128 v[72:75], v48 offset:4096
    ds_read_b128 v[76:79], v48 offset:5120
    ds_read_b128 v[120:123], v48 offset:6144
    ds_read_b128 v[124:127], v48 offset:7168
    ds_read_b128 v[128:131], v49 offset:0
    ds_read_b128 v[132:135], v49 offset:1024
    ds_read_b128 v[136:139], v49 offset:2048
    ds_read_b128 v[140:143], v49 offset:3072
    s_waitcnt lgkmcnt(4)
    v_mfma_f32_16x16x32_bf16 v[80:83], v[72:75], v[56:59], v[80:83]
    v_mfma_f32_16x16x32_bf16 v[80:83], v[76:79], v[60:63], v[80:83]
    v_mfma_f32_16x16x32_bf16 v[80:83], v[120:123], v[64:67], v[80:83]
    v_mfma_f32_16x16x32_bf16 v[80:83], v[124:127], v[68:71], v[80:83]
    ds_read_b128 v[72:75], v50 offset:0
    ds_read_b128 v[76:79], v50 offset:1024
    ds_read_b128 v[120:123], v50 offset:2048
    ds_read_b128 v[124:127], v50 offset:3072
    v_pk_mul_f32 v[36:37], v[42:43], v[30:31] op_sel:[0,0] op_sel_hi:[0,1]
    v_pk_fma_f32 v[40:41], v[42:43], v[30:31], v[36:37] op_sel:[1,1,0] op_sel_hi:[1,0,1] neg_lo:[1,0,0]
    v_pk_mul_f32 v[36:37], v[40:41], v[30:31] op_sel:[0,0] op_sel_hi:[0,1]
    v_pk_fma_f32 v[42:43], v[40:41], v[30:31], v[36:37] op_sel:[1,1,0] op_sel_hi:[1,0,1] neg_lo:[1,0,0]
    v_mov_b32 v32, v40
    v_mov_b32 v33, v41
    v_mov_b32 v34, v42
    v_mov_b32 v35, v43
    v_cvt_pk_bf16_f32 v118, v32, v33
    v_cvt_pk_bf16_f32 v119, v34, v35
    ds_write_b32 v145, v119 offset:320
    v_pk_mul_f32 v[36:37], v[32:33], v[24:25] op_sel:[0,0] op_sel_hi:[0,1]
    v_pk_mul_f32 v[38:39], v[34:35], v[26:27] op_sel:[0,0] op_sel_hi:[0,1]
    v_pk_fma_f32 v[32:33], v[32:33], v[24:25], v[36:37] op_sel:[1,1,0] op_sel_hi:[1,0,1] neg_lo:[1,0,0]
    v_pk_fma_f32 v[34:35], v[34:35], v[26:27], v[38:39] op_sel:[1,1,0] op_sel_hi:[1,0,1] neg_lo:[1,0,0]
    v_cvt_pk_bf16_f32 v112, v32, v33
    ds_write2_b32 v144, v118, v112 offset0:0 offset1:16
    v_cvt_pk_bf16_f32 v113, v34, v35
    v_pk_mul_f32 v[36:37], v[32:33], v[24:25] op_sel:[0,0] op_sel_hi:[0,1]
    v_pk_mul_f32 v[38:39], v[34:35], v[26:27] op_sel:[0,0] op_sel_hi:[0,1]
    v_pk_fma_f32 v[32:33], v[32:33], v[24:25], v[36:37] op_sel:[1,1,0] op_sel_hi:[1,0,1] neg_lo:[1,0,0]
    v_pk_fma_f32 v[34:35], v[34:35], v[26:27], v[38:39] op_sel:[1,1,0] op_sel_hi:[1,0,1] neg_lo:[1,0,0]
    v_cvt_pk_bf16_f32 v114, v32, v33
    v_cvt_pk_bf16_f32 v115, v34, v35
    ds_write2_b32 v145, v113, v115 offset0:96 offset1:112
    v_pk_mul_f32 v[36:37], v[32:33], v[24:25] op_sel:[0,0] op_sel_hi:[0,1]
    v_pk_fma_f32 v[32:33], v[32:33], v[24:25], v[36:37] op_sel:[1,1,0] op_sel_hi:[1,0,1] neg_lo:[1,0,0]
    v_cvt_pk_bf16_f32 v116, v32, v33
    ds_write2_b32 v144, v114, v116 offset0:32 offset1:48
    v_pk_mul_f32 v[36:37], v[32:33], v[24:25] op_sel:[0,0] op_sel_hi:[0,1]
    v_pk_fma_f32 v[32:33], v[32:33], v[24:25], v[36:37] op_sel:[1,1,0] op_sel_hi:[1,0,1] neg_lo:[1,0,0]
    v_cvt_pk_bf16_f32 v117, v32, v33
    ds_write_b32 v145, v117 offset:256
    v_pk_mul_f32 v[36:37], v[42:43], v[30:31] op_sel:[0,0] op_sel_hi:[0,1]
    v_pk_fma_f32 v[40:41], v[42:43], v[30:31], v[36:37] op_sel:[1,1,0] op_sel_hi:[1,0,1] neg_lo:[1,0,0]
    v_pk_mul_f32 v[36:37], v[40:41], v[30:31] op_sel:[0,0] op_sel_hi:[0,1]
    v_pk_fma_f32 v[42:43], v[40:41], v[30:31], v[36:37] op_sel:[1,1,0] op_sel_hi:[1,0,1] neg_lo:[1,0,0]
    v_mov_b32 v32, v40
    v_mov_b32 v33, v41
    v_mov_b32 v34, v42
    v_mov_b32 v35, v43
    v_cvt_pk_bf16_f32 v118, v32, v33
    v_cvt_pk_bf16_f32 v119, v34, v35
    ds_write_b32 v146, v119 offset:704
    v_pk_mul_f32 v[36:37], v[32:33], v[26:27] op_sel:[0,0] op_sel_hi:[0,1]
    v_pk_mul_f32 v[38:39], v[34:35], v[26:27] op_sel:[0,0] op_sel_hi:[0,1]
    v_pk_fma_f32 v[32:33], v[32:33], v[26:27], v[36:37] op_sel:[1,1,0] op_sel_hi:[1,0,1] neg_lo:[1,0,0]
    v_pk_fma_f32 v[34:35], v[34:35], v[26:27], v[38:39] op_sel:[1,1,0] op_sel_hi:[1,0,1] neg_lo:[1,0,0]
    v_cvt_pk_bf16_f32 v112, v32, v33
    ds_write2_b32 v146, v118, v112 offset0:128 offset1:144
    v_cvt_pk_bf16_f32 v113, v34, v35
    v_pk_mul_f32 v[36:37], v[32:33], v[26:27] op_sel:[0,0] op_sel_hi:[0,1]
    v_pk_mul_f32 v[38:39], v[34:35], v[26:27] op_sel:[0,0] op_sel_hi:[0,1]
    v_pk_fma_f32 v[32:33], v[32:33], v[26:27], v[36:37] op_sel:[1,1,0] op_sel_hi:[1,0,1] neg_lo:[1,0,0]
    v_pk_fma_f32 v[34:35], v[34:35], v[26:27], v[38:39] op_sel:[1,1,0] op_sel_hi:[1,0,1] neg_lo:[1,0,0]
    v_cvt_pk_bf16_f32 v114, v32, v33
    ds_write_b32 v146, v114 offset:640
    v_cvt_pk_bf16_f32 v115, v34, v35
    ds_write2_b32 v147, v113, v115 offset0:192 offset1:208
    s_cmp_lg_u32 s68, 1
    s_cbranch_scc1 L_h0_9
    global_load_dwordx2 v[152:153], v150, s[64:65] sc1
L_h0_9:
    s_setprio 0
    s_barrier
    s_cmp_lg_u32 s77, 0
    s_cbranch_scc1 L_ng_15
    ds_read_b64_tr_b16 v[154:155], v162 offset:0
    ds_read_b64_tr_b16 v[156:157], v163 offset:512
    ds_read_b64_tr_b16 v[158:159], v162 offset:4096
    ds_read_b64_tr_b16 v[160:161], v163 offset:4608
    s_waitcnt lgkmcnt(0)
L_ng_15:
    s_setprio 2
    s_waitcnt lgkmcnt(0)
    v_mfma_f32_16x16x32_bf16 v[84:87], v[128:131], v[56:59], v[84:87]
    v_mfma_f32_16x16x32_bf16 v[84:87], v[132:135], v[60:63], v[84:87]
    v_mfma_f32_16x16x32_bf16 v[84:87], v[136:139], v[64:67], v[84:87]
    v_mfma_f32_16x16x32_bf16 v[84:87], v[140:143], v[68:71], v[84:87]
    v_mfma_f32_16x16x32_bf16 v[88:91], v[72:75], v[56:59], v[88:91]
    v_mfma_f32_16x16x32_bf16 v[88:91], v[76:79], v[60:63], v[88:91]
    v_mfma_f32_16x16x32_bf16 v[88:91], v[120:123], v[64:67], v[88:91]
    v_mfma_f32_16x16x32_bf16 v[88:91], v[124:127], v[68:71], v[88:91]
    ds_read_b128 v[72:75], v51 offset:4096
    ds_read_b128 v[76:79], v51 offset:5120
    ds_read_b128 v[120:123], v51 offset:6144
    ds_read_b128 v[124:127], v51 offset:7168
    ds_read_b128 v[128:131], v52 offset:4096
    ds_read_b128 v[132:135], v52 offset:5120
    ds_read_b128 v[136:139], v52 offset:6144
    ds_read_b128 v[140:143], v52 offset:7168
    v_pk_mul_f32 v[36:37], v[42:43], v[30:31] op_sel:[0,0] op_sel_hi:[0,1]
    v_pk_fma_f32 v[40:41], v[42:43], v[30:31], v[36:37] op_sel:[1,1,0] op_sel_hi:[1,0,1] neg_lo:[1,0,0]
    v_mov_b32 v32, v40
    v_mov_b32 v33, v41
    v_cvt_pk_bf16_f32 v116, v32, v33
    v_pk_mul_f32 v[36:37], v[32:33], v[26:27] op_sel:[0,0] op_sel_hi:[0,1]
    v_pk_fma_f32 v[32:33], v[32:33], v[26:27], v[36:37] op_sel:[1,1,0] op_sel_hi:[1,0,1] neg_lo:[1,0,0]
    v_cvt_pk_bf16_f32 v117, v32, v33
    ds_write2_b32 v44, v116, v117 offset0:0 offset1:16
    v_pk_mul_f32 v[36:37], v[32:33], v[26:27] op_sel:[0,0] op_sel_hi:[0,1]
    v_pk_fma_f32 v[32:33], v[32:33], v[26:27], v[36:37] op_sel:[1,1,0] op_sel_hi:[1,0,1] neg_lo:[1,0,0]
    v_cvt_pk_bf16_f32 v118, v32, v33
    ds_write_b32 v44, v118 offset:128
    s_waitcnt lgkmcnt(6)
    v_mfma_f32_16x16x32_bf16 v[92:95], v[72:75], v[56:59], v[92:95]
    v_mfma_f32_16x16x32_bf16 v[92:95], v[76:79], v[60:63], v[92:95]
    v_mfma_f32_16x16x32_bf16 v[92:95], v[120:123], v[64:67], v[92:95]
    v_mfma_f32_16x16x32_bf16 v[92:95], v[124:127], v[68:71], v[92:95]
    s_setprio 0
    s_cmp_lg_u32 s68, 1
    s_cbranch_scc1 L_hnf_10
    v_lshlrev_b32 v1, 2, v0
    v_add_u32 v1, 158464, v1
    ds_read_b32 v4, v1
    s_waitcnt vmcnt(0)
    s_mov_b32 s7, 0
L_npoll_16:
    v_readfirstlane_b32 s70, v152
    v_readfirstlane_b32 s71, v153
    s_add_u32 s7, s7, 1
    s_cmp_lg_u32 s70, 0
    s_cbranch_scc1 L_nok_17
    s_cmp_gt_u32 s7, 200000
    s_cbranch_scc1 L_nok_17
    global_load_dwordx2 v[152:153], v150, s[64:65] sc1
    s_waitcnt vmcnt(0)
    s_branch L_npoll_16
L_nok_17:
    s_add_u32 s24, s66, 18874368
    s_addc_u32 s25, s67, 0
    s_mov_b32 s26, 16384
    s_mov_b32 s27, 0x20000
    s_lshl_b32 s32, s4, 4
    s_add_u32 s32, s32, s5
    s_lshl_b32 s32, s32, 6
    v_lshlrev_b32 v1, 3, v0
    v_mov_b32 v5, s70
    s_waitcnt lgkmcnt(0)
    s_mov_b64 exec, 0xff
    s_setprio 3
    buffer_store_dwordx2 v[4:5], v1, s[24:27], s32 offen sc1
    s_setprio 0
    s_mov_b64 exec, 1
    v_mov_b32 v1, 158528
    ds_write_b64 v1, v[152:153]
    s_mov_b64 exec, -1
    s_waitcnt lgkmcnt(0)
L_hnf_10:
    s_barrier
    s_cmp_lg_u32 s77, 1
    s_cbranch_scc1 L_ng_18
    ds_read_b64_tr_b16 v[154:155], v162 offset:40960
    ds_read_b64_tr_b16 v[156:157], v163 offset:41472
    ds_read_b64_tr_b16 v[158:159], v162 offset:45056
    ds_read_b64_tr_b16 v[160:161], v163 offset:45568
    s_waitcnt lgkmcnt(0)
L_ng_18:
    s_setprio 2
    ds_read_b128 v[72:75], v53 offset:4096
    ds_read_b128 v[76:79], v53 offset:5120
    ds_read_b128 v[120:123], v53 offset:6144
    ds_read_b128 v[124:127], v53 offset:7168
    s_waitcnt lgkmcnt(4)
    v_mfma_f32_16x16x32_bf16 v[96:99], v[128:131], v[56:59], v[96:99]
    v_mfma_f32_16x16x32_bf16 v[96:99], v[132:135], v[60:63], v[96:99]
    v_mfma_f32_16x16x32_bf16 v[96:99], v[136:139], v[64:67], v[96:99]
    v_mfma_f32_16x16x32_bf16 v[96:99], v[140:143], v[68:71], v[96:99]
    ds_read_b128 v[128:131], v54 offset:4096
    ds_read_b128 v[132:135], v54 offset:5120
    ds_read_b128 v[136:139], v54 offset:6144
    ds_read_b128 v[140:143], v54 offset:7168
    s_waitcnt lgkmcnt(4)
    v_mfma_f32_16x16x32_bf16 v[100:103], v[72:75], v[56:59], v[100:103]
    v_mfma_f32_16x16x32_bf16 v[100:103], v[76:79], v[60:63], v[100:103]
    v_mfma_f32_16x16x32_bf16 v[100:103], v[120:123], v[64:67], v[100:103]
    v_mfma_f32_16x16x32_bf16 v[100:103], v[124:127], v[68:71], v[100:103]
    ds_read_b128 v[72:75], v55 offset:0
    ds_read_b128 v[76:79], v55 offset:1024
    ds_read_b128 v[120:123], v55 offset:2048
    ds_read_b128 v[124:127], v55 offset:3072
    s_waitcnt lgkmcnt(4)
    v_mfma_f32_16x16x32_bf16 v[104:107], v[128:131], v[56:59], v[104:107]
    v_mfma_f32_16x16x32_bf16 v[104:107], v[132:135], v[60:63], v[104:107]
    v_mfma_f32_16x16x32_bf16 v[104:107], v[136:139], v[64:67], v[104:107]
    v_mfma_f32_16x16x32_bf16 v[104:107], v[140:143], v[68:71], v[104:107]
    s_setprio 0
    s_waitcnt lgkmcnt(0)
    s_barrier
    s_setprio 2
    s_waitcnt lgkmcnt(0)
    v_mfma_f32_16x16x32_bf16 v[108:111], v[72:75], v[56:59], v[108:111]
    v_mfma_f32_16x16x32_bf16 v[108:111], v[76:79], v[60:63], v[108:111]
    v_mfma_f32_16x16x32_bf16 v[108:111], v[120:123], v[64:67], v[108:111]
    v_mfma_f32_16x16x32_bf16 v[108:111], v[124:127], v[68:71], v[108:111]
    s_bitcmp0_b32 s68, 0
    s_cbranch_scc1 L_hrest_11
    s_setprio 3
    v_mov_b32 v1, 158528
    ds_read_b32 v11, v1
    v_lshrrev_b32 v2, 5, v0
    v_lshrrev_b32 v3, 4, v0
    v_and_b32 v3, 1, v3
    v_mul_u32_u24 v4, 12288, v3
    v_lshlrev_b32 v5, 9, v2
    v_add_u32 v4, v4, v5
    v_and_b32 v5, 15, v0
    v_lshrrev_b32 v6, 2, v5
    v_lshlrev_b32 v6, 6, v6
    v_add_u32 v4, v4, v6
    v_and_b32 v5, 3, v5
    v_lshlrev_b32 v5, 3, v5
    v_add_u32 v4, v4, v5
    s_lshr_b32 s7, s4, 3
    s_lshl_b32 s7, s7, 11
    s_add_u32 s7, s7, 98304
    v_add_u32 v4, s7, v4
    s_lshr_b32 s72, s68, 1
    s_mul_i32 s73, s72, 3
    s_add_u32 s32, s73, 0
    s_lshr_b32 s33, s32, 1
    s_lshl_b32 s33, s33, 12
    s_and_b32 s32, s32, 1
    v_xor_b32 v5, s32, v3
    v_lshlrev_b32 v5, 5, v5
    v_add_u32 v5, s33, v5
    v_add_u32 v8, v4, v5
    s_add_u32 s32, s73, 1
    s_lshr_b32 s33, s32, 1
    s_lshl_b32 s33, s33, 12
    s_and_b32 s32, s32, 1
    v_xor_b32 v5, s32, v3
    v_lshlrev_b32 v5, 5, v5
    v_add_u32 v5, s33, v5
    v_add_u32 v9, v4, v5
    s_add_u32 s32, s73, 2
    s_lshr_b32 s33, s32, 1
    s_lshl_b32 s33, s33, 12
    s_and_b32 s32, s32, 1
    v_xor_b32 v5, s32, v3
    v_lshlrev_b32 v5, 5, v5
    v_add_u32 v5, s33, v5
    v_add_u32 v10, v4, v5
    ds_read_b64_tr_b16 v[16:17], v8 offset:0
    ds_read_b64_tr_b16 v[18:19], v8 offset:256
    ds_read_b64_tr_b16 v[20:21], v8 offset:1024
    ds_read_b64_tr_b16 v[22:23], v8 offset:1280
    ds_read_b64_tr_b16 v[24:25], v9 offset:0
    ds_read_b64_tr_b16 v[26:27], v9 offset:256
    ds_read_b64_tr_b16 v[28:29], v9 offset:1024
    ds_read_b64_tr_b16 v[30:31], v9 offset:1280
    ds_read_b64_tr_b16 v[32:33], v10 offset:0
    ds_read_b64_tr_b16 v[34:35], v10 offset:256
    ds_read_b64_tr_b16 v[36:37], v10 offset:1024
    ds_read_b64_tr_b16 v[38:39], v10 offset:1280
    v_and_b32 v5, 15, v0
    v_cmp_eq_u32 vcc, v5, v3
    v_mov_b32 v6, 0x3f803f80
    v_mov_b32 v7, 0
    v_cndmask_b32 v12, v7, v6, vcc
    v_mov_b32 v13, v12
    v_mov_b32 v14, v12
    v_mov_b32 v15, v12
    v_mov_b32 v112, 0
    v_mov_b32 v113, 0
    v_mov_b32 v114, 0
    v_mov_b32 v115, 0
    v_mov_b32 v116, 0
    v_mov_b32 v117, 0
    v_mov_b32 v118, 0
    v_mov_b32 v119, 0
    v_mov_b32 v120, 0
    v_mov_b32 v121, 0
    v_mov_b32 v122, 0
    v_mov_b32 v123, 0
    s_add_u32 s20, s66, 18939904
    s_addc_u32 s21, s67, 0
    s_mov_b32 s22, 262144
    s_mov_b32 s23, 0x20000
    s_waitcnt lgkmcnt(0)
    v_mfma_f32_16x16x32_bf16 v[112:115], v[16:19], v[12:15], v[112:115]
    v_mfma_f32_16x16x32_bf16 v[116:119], v[24:27], v[12:15], v[116:119]
    v_mfma_f32_16x16x32_bf16 v[120:123], v[32:35], v[12:15], v[120:123]
    v_mfma_f32_16x16x32_bf16 v[112:115], v[20:23], v[12:15], v[112:115]
    v_mfma_f32_16x16x32_bf16 v[116:119], v[28:31], v[12:15], v[116:119]
    v_mfma_f32_16x16x32_bf16 v[120:123], v[36:39], v[12:15], v[120:123]
    v_and_b32 v5, 15, v0
    v_lshlrev_b32 v1, 6, v5
    v_lshrrev_b32 v2, 4, v0
    v_lshlrev_b32 v2, 4, v2
    v_add_u32 v1, v1, v2
    s_lshl_b32 s7, s5, 4
    s_add_u32 s7, s7, s4
    s_lshl_b32 s33, s7, 10
    s_lshl_b32 s7, s72, 9
    s_add_u32 s33, s33, s7
    v_cmp_gt_u32 vcc, 2, v5
    v_mov_b32 v19, v11
    v_mov_b32 v23, v11
    v_mov_b32 v27, v11
    v_mov_b32 v31, v11
    v_mov_b32 v16, v112
    v_mov_b32 v17, v113
    v_mov_b32 v18, v114
    v_mov_b32 v20, v115
    v_mov_b32 v21, v116
    v_mov_b32 v22, v117
    v_mov_b32 v24, v118
    v_mov_b32 v25, v119
    v_mov_b32 v26, v120
    v_mov_b32 v28, v121
    v_mov_b32 v29, v122
    v_mov_b32 v30, v123
    s_and_saveexec_b64 s[34:35], vcc
    buffer_store_dwordx4 v[16:19], v1, s[20:23], s33 offen offset:0 sc1
    buffer_store_dwordx4 v[20:23], v1, s[20:23], s33 offen offset:128 sc1
    buffer_store_dwordx4 v[24:27], v1, s[20:23], s33 offen offset:256 sc1
    buffer_store_dwordx4 v[28:31], v1, s[20:23], s33 offen offset:384 sc1
    s_mov_b64 exec, s[34:35]
L_hrest_11:
    s_setprio 0
    s_barrier
    s_add_u32 s24, s66, 18874368
    s_addc_u32 s25, s67, 0
    s_mov_b32 s26, 16384
    s_mov_b32 s27, 0x20000
    v_mov_b32 v1, 158528
    ds_read_b64 v[164:165], v1
    v_lshlrev_b32 v8, 4, v0
    s_lshl_b32 s72, s4, 10
    s_cmp_lg_u32 s68, 0
    s_cbranch_scc1 L_hg1_13
    s_setprio 3
    buffer_load_dwordx4 v[12:15], v8, s[24:27], s72 offen sc1
    s_setprio 0
L_hg1_13:
    s_waitcnt lgkmcnt(0)
    s_barrier
    s_cmp_lg_u32 s68, 0
    s_cbranch_scc1 L_hg2_14
    s_mov_b32 s75, 0
L_schk_19:
    s_waitcnt vmcnt(0)
    v_cmp_ne_u32 vcc, v164, v13
    v_cmp_ne_u32 s[32:33], v164, v15
    s_or_b64 vcc, vcc, s[32:33]
    s_add_u32 s75, s75, 1
    s_cmp_eq_u64 vcc, 0
    s_cbranch_scc1 L_sok_20
    s_cmp_gt_u32 s75, 200000
    s_cbranch_scc1 L_sok_20
    buffer_load_dwordx4 v[12:15], v8, s[24:27], s72 offen sc1
    s_branch L_schk_19
L_sok_20:
    v_lshlrev_b32 v4, 16, v12
    v_and_b32 v5, 0xffff0000, v12
    v_lshlrev_b32 v6, 16, v14
    v_and_b32 v7, 0xffff0000, v14
    v_lshlrev_b32 v1, 4, v0
    v_add_u32 v1, 155648, v1
    ds_write_b128 v1, v[4:7]
    v_rcp_f32 v10, v5
    v_rcp_f32 v11, v7
    v_mov_b32 v5, v6
    v_lshlrev_b32 v1, 3, v0
    v_add_u32 v1, 157440, v1
    ds_write_b64 v1, v[4:5]
    ds_write_b64 v1, v[10:11] offset:512
    s_waitcnt lgkmcnt(0)
L_hg2_14:
    s_barrier
    s_add_u32 s20, s66, 8388608
    s_addc_u32 s21, s67, 0
    s_mov_b32 s22, 2097152
    s_mov_b32 s23, 0x20000
    v_lshrrev_b32 v3, 4, v0
    v_and_b32 v1, 15, v0
    s_and_b32 s7, s68, 1
    s_lshl_b32 s7, s7, 4
    v_add_u32 v1, s7, v1
    v_lshlrev_b32 v1, 12, v1
    v_lshlrev_b32 v5, 4, v3
    v_add_u32 v8, v1, v5
    s_lshl_b32 s32, s87, 17
    s_lshl_b32 s33, s4, 8
    s_add_u32 s32, s32, s33
    s_lshr_b32 s7, s68, 1
    s_lshl_b32 s33, s7, 7
    s_add_u32 s32, s32, s33
    v_lshlrev_b32 v9, 5, v3
    s_lshl_b32 s33, s7, 8
    s_add_u32 s33, s33, 157440
    v_add_u32 v9, s33, v9
    ds_read_b128 v[16:19], v9 offset:0
    ds_read_b128 v[20:23], v9 offset:16
    ds_read_b128 v[24:27], v9 offset:512
    ds_read_b128 v[28:31], v9 offset:528
    ds_read_b128 v[32:35], v9 offset:128
    ds_read_b128 v[36:39], v9 offset:144
    ds_read_b128 v[40:43], v9 offset:640
    ds_read_b128 v[44:47], v9 offset:656
    v_lshlrev_b32 v48, 16, v154
    v_and_b32 v49, 0xffff0000, v154
    v_lshlrev_b32 v50, 16, v155
    v_and_b32 v51, 0xffff0000, v155
    v_lshlrev_b32 v52, 16, v156
    v_and_b32 v53, 0xffff0000, v156
    v_lshlrev_b32 v54, 16, v157
    v_and_b32 v55, 0xffff0000, v157
    s_waitcnt lgkmcnt(4)
    v_sub_f32 v48, v48, v16
    v_sub_f32 v49, v49, v17
    v_sub_f32 v50, v50, v18
    v_sub_f32 v51, v51, v19
    v_sub_f32 v52, v52, v20
    v_sub_f32 v53, v53, v21
    v_sub_f32 v54, v54, v22
    v_sub_f32 v55, v55, v23
    v_cvt_pk_bf16_f32 v56, v48, v49
    v_cvt_pk_bf16_f32 v57, v50, v51
    v_cvt_pk_bf16_f32 v58, v52, v53
    v_cvt_pk_bf16_f32 v59, v54, v55
    v_lshlrev_b32 v48, 16, v56
    v_and_b32 v49, 0xffff0000, v56
    v_lshlrev_b32 v50, 16, v57
    v_and_b32 v51, 0xffff0000, v57
    v_lshlrev_b32 v52, 16, v58
    v_and_b32 v53, 0xffff0000, v58
    v_lshlrev_b32 v54, 16, v59
    v_and_b32 v55, 0xffff0000, v59
    v_mul_f32 v48, v48, v24
    v_mul_f32 v49, v49, v25
    v_mul_f32 v50, v50, v26
    v_mul_f32 v51, v51, v27
    v_mul_f32 v52, v52, v28
    v_mul_f32 v53, v53, v29
    v_mul_f32 v54, v54, v30
    v_mul_f32 v55, v55, v31
    v_cvt_pk_bf16_f32 v56, v48, v49
    v_cvt_pk_bf16_f32 v57, v50, v51
    v_cvt_pk_bf16_f32 v58, v52, v53
    v_cvt_pk_bf16_f32 v59, v54, v55
    s_setprio 3
    buffer_store_dwordx4 v[56:59], v8, s[20:23], s32 offen offset:0 sc1
    s_setprio 0
    v_lshlrev_b32 v60, 16, v158
    v_and_b32 v61, 0xffff0000, v158
    v_lshlrev_b32 v62, 16, v159
    v_and_b32 v63, 0xffff0000, v159
    v_lshlrev_b32 v64, 16, v160
    v_and_b32 v65, 0xffff0000, v160
    v_lshlrev_b32 v66, 16, v161
    v_and_b32 v67, 0xffff0000, v161
    s_waitcnt lgkmcnt(0)
    v_sub_f32 v60, v60, v32
    v_sub_f32 v61, v61, v33
    v_sub_f32 v62, v62, v34
    v_sub_f32 v63, v63, v35
    v_sub_f32 v64, v64, v36
    v_sub_f32 v65, v65, v37
    v_sub_f32 v66, v66, v38
    v_sub_f32 v67, v67, v39
    v_cvt_pk_bf16_f32 v68, v60, v61
    v_cvt_pk_bf16_f32 v69, v62, v63
    v_cvt_pk_bf16_f32 v70, v64, v65
    v_cvt_pk_bf16_f32 v71, v66, v67
    v_lshlrev_b32 v60, 16, v68
    v_and_b32 v61, 0xffff0000, v68
    v_lshlrev_b32 v62, 16, v69
    v_and_b32 v63, 0xffff0000, v69
    v_lshlrev_b32 v64, 16, v70
    v_and_b32 v65, 0xffff0000, v70
    v_lshlrev_b32 v66, 16, v71
    v_and_b32 v67, 0xffff0000, v71
    v_mul_f32 v60, v60, v40
    v_mul_f32 v61, v61, v41
    v_mul_f32 v62, v62, v42
    v_mul_f32 v63, v63, v43
    v_mul_f32 v64, v64, v44
    v_mul_f32 v65, v65, v45
    v_mul_f32 v66, v66, v46
    v_mul_f32 v67, v67, v47
    v_cvt_pk_bf16_f32 v68, v60, v61
    v_cvt_pk_bf16_f32 v69, v62, v63
    v_cvt_pk_bf16_f32 v70, v64, v65
    v_cvt_pk_bf16_f32 v71, v66, v67
    s_setprio 3
    buffer_store_dwordx4 v[68:71], v8, s[20:23], s32 offen offset:64 sc1
    s_setprio 0
    s_barrier
    s_barrier
    s_waitcnt vmcnt(0)
    v_mov_b32 v1, 158540
    v_mov_b32 v2, 1
    s_mov_b64 exec, 1
    ds_add_rtn_u32 v3, v1, v2
    s_mov_b64 exec, -1
    s_waitcnt lgkmcnt(0)
    v_readfirstlane_b32 s7, v3
    s_cmp_lg_u32 s7, 3
    s_cbranch_scc1 L_nfx_21
    s_lshl_b32 s30, s4, 4
    s_add_u32 s30, s30, s87
    s_lshl_b32 s7, s30, 7
    s_add_u32 s7, s7, 19529728
    v_mov_b32 v1, s7
    s_mov_b64 exec, 1
    global_store_dwordx2 v1, v[164:165], s[66:67] sc1
    s_mov_b64 exec, -1
L_nfx_21:
    s_and_b32 s7, s68, 1
    s_cmp_eq_u32 s7, 0
    s_cbranch_scc1 L_heven_12
    v_lshlrev_b32 v1, 4, v0
    v_add_u32 v1, s69, v1
    ds_write_b128 v1, v[80:83] offset:0
    ds_write_b128 v1, v[84:87] offset:1024
    ds_write_b128 v1, v[88:91] offset:2048
    ds_write_b128 v1, v[92:95] offset:3072
    ds_write_b128 v1, v[96:99] offset:4096
    ds_write_b128 v1, v[100:103] offset:5120
    ds_write_b128 v1, v[104:107] offset:6144
    ds_write_b128 v1, v[108:111] offset:7168
    s_waitcnt lgkmcnt(0)
    s_lshr_b32 s7, s68, 1
    s_lshl_b32 s7, s7, 2
    s_add_u32 s7, s7, 158592
    v_mov_b32 v1, s7
    v_mov_b32 v2, 1
    ds_write_b32 v1, v2
L_heven_12:
    s_setprio 0
    v_mov_b32 v1, 158528
    ds_read_b64 v[164:165], v1
    s_sub_u32 s80, s3, 4
    s_lshr_b32 s73, s68, 1
    s_and_b32 s72, s68, 1
    s_lshl_b32 s71, s2, 1
    s_add_u32 s71, s71, s73
    s_mul_i32 s70, s73, 12928
    s_add_u32 s70, s70, 0
    s_and_b32 s7, s2, 7
    s_lshr_b32 s33, s2, 3
    s_lshr_b32 s78, s7, 1
    s_lshl_b32 s78, s78, 3
    s_and_b32 s79, s33, 7
    s_add_u32 s78, s78, s79
    s_and_b32 s7, s7, 1
    s_lshl_b32 s7, s7, 2
    s_lshr_b32 s79, s33, 3
    s_add_u32 s79, s79, s7
    s_and_b32 s32, s80, 3
    s_lshl_b32 s32, s32, 4
    s_lshl_b32 s33, s78, 6
    s_add_u32 s32, s32, s33
    v_and_b32 v2, 15, v0
    v_add_u32 v2, s32, v2
    v_lshlrev_b32 v2, 10, v2
    s_lshr_b32 s32, s80, 2
    s_lshl_b32 s32, s32, 6
    s_lshl_b32 s33, s79, 7
    s_add_u32 s32, s32, s33
    v_lshrrev_b32 v3, 4, v0
    v_lshlrev_b32 v3, 4, v3
    v_add_u32 v2, v2, v3
    v_add_u32 v166, s32, v2
    s_mov_b32 s8, s66
    s_mov_b32 s9, s67
    s_mov_b32 s10, 19922944
    s_mov_b32 s11, 0x20000
    s_cmp_eq_u32 s72, 1
    s_cbranch_scc1 L_codd_22
    s_lshl_b32 s26, s73, 2
    s_add_u32 s26, s26, 158592
    v_mov_b32 v1, s26
    s_mov_b32 s99, 0
L_spin_24:
    ds_read_b32 v3, v1
    s_add_u32 s99, s99, 1
    s_waitcnt lgkmcnt(0)
    v_readfirstlane_b32 s24, v3
    s_cmp_gt_u32 s99, 1000000
    s_cselect_b32 s24, 1, s24
    s_cmp_eq_u32 s24, 0
    s_cbranch_scc1 L_spin_24
    v_lshlrev_b32 v1, 4, v0
    v_add_u32 v2, s69, v1
    ds_read_b128 v[16:19], v2 offset:8192
    ds_read_b128 v[20:23], v2 offset:9216
    ds_read_b128 v[24:27], v2 offset:10240
    ds_read_b128 v[28:31], v2 offset:11264
    ds_read_b128 v[32:35], v2 offset:12288
    ds_read_b128 v[36:39], v2 offset:13312
    ds_read_b128 v[40:43], v2 offset:14336
    ds_read_b128 v[44:47], v2 offset:15360
    v_and_b32 v2, 15, v0
    v_lshlrev_b32 v2, 5, v2
    v_lshrrev_b32 v3, 4, v0
    v_lshlrev_b32 v3, 3, v3
    v_add_u32 v2, v2, v3
    v_sub_u32 v2, 504, v2
    s_add_u32 s7, s70, 4608
    v_add_u32 v2, s7, v2
    s_waitcnt lgkmcnt(7)
    v_add_f32 v80, v80, v16
    v_add_f32 v81, v81, v17
    v_add_f32 v82, v82, v18
    v_add_f32 v83, v83, v19
    v_cvt_pk_bf16_f32 v48, v83, v82
    v_cvt_pk_bf16_f32 v49, v81, v80
    s_waitcnt lgkmcnt(6)
    v_add_f32 v84, v84, v20
    v_add_f32 v85, v85, v21
    v_add_f32 v86, v86, v22
    v_add_f32 v87, v87, v23
    v_cvt_pk_bf16_f32 v50, v87, v86
    v_cvt_pk_bf16_f32 v51, v85, v84
    s_waitcnt lgkmcnt(5)
    v_add_f32 v88, v88, v24
    v_add_f32 v89, v89, v25
    v_add_f32 v90, v90, v26
    v_add_f32 v91, v91, v27
    v_cvt_pk_bf16_f32 v52, v91, v90
    v_cvt_pk_bf16_f32 v53, v89, v88
    s_waitcnt lgkmcnt(4)
    v_add_f32 v92, v92, v28
    v_add_f32 v93, v93, v29
    v_add_f32 v94, v94, v30
    v_add_f32 v95, v95, v31
    v_cvt_pk_bf16_f32 v54, v95, v94
    v_cvt_pk_bf16_f32 v55, v93, v92
    s_waitcnt lgkmcnt(3)
    v_add_f32 v96, v96, v32
    v_add_f32 v97, v97, v33
    v_add_f32 v98, v98, v34
    v_add_f32 v99, v99, v35
    v_cvt_pk_bf16_f32 v56, v99, v98
    v_cvt_pk_bf16_f32 v57, v97, v96
    s_waitcnt lgkmcnt(2)
    v_add_f32 v100, v100, v36
    v_add_f32 v101, v101, v37
    v_add_f32 v102, v102, v38
    v_add_f32 v103, v103, v39
    v_cvt_pk_bf16_f32 v58, v103, v102
    v_cvt_pk_bf16_f32 v59, v101, v100
    s_waitcnt lgkmcnt(1)
    v_add_f32 v104, v104, v40
    v_add_f32 v105, v105, v41
    v_add_f32 v106, v106, v42
    v_add_f32 v107, v107, v43
    v_cvt_pk_bf16_f32 v60, v107, v106
    v_cvt_pk_bf16_f32 v61, v105, v104
    s_waitcnt lgkmcnt(0)
    v_add_f32 v108, v108, v44
    v_add_f32 v109, v109, v45
    v_add_f32 v110, v110, v46
    v_add_f32 v111, v111, v47
    v_cvt_pk_bf16_f32 v62, v111, v110
    v_cvt_pk_bf16_f32 v63, v109, v108
    ds_write_b64 v2, v[48:49] offset:3584
    ds_write_b64 v2, v[50:51] offset:3072
    ds_write_b64 v2, v[52:53] offset:2560
    ds_write_b64 v2, v[54:55] offset:2048
    ds_write_b64 v2, v[56:57] offset:1536
    ds_write_b64 v2, v[58:59] offset:1024
    ds_write_b64 v2, v[60:61] offset:512
    ds_write_b64 v2, v[62:63] offset:0
    v_mov_b32 v6, 0
    v_mov_b32 v7, 0
    v_lshlrev_b32 v3, 3, v0
    s_add_u32 s7, s70, 8704
    v_add_u32 v2, s7, v3
    s_mov_b64 exec, 0xff
    ds_write_b64 v2, v[6:7]
    ds_write_b64 v2, v[6:7] offset:4160
    s_mov_b64 exec, -1
    s_add_u32 s7, s70, 4608
    v_add_u32 v2, s7, v1
    ds_read_b128 v[16:19], v2 offset:0
    ds_read_b32 v20, v2 offset:16
    ds_read_b128 v[24:27], v2 offset:1024
    ds_read_b32 v28, v2 offset:1040
    ds_read_b128 v[32:35], v2 offset:2048
    ds_read_b32 v36, v2 offset:2064
    ds_read_b128 v[40:43], v2 offset:3072
    ds_read_b32 v44, v2 offset:3088
    s_waitcnt lgkmcnt(6)
    v_alignbit_b32 v48, v17, v16, 16
    v_alignbit_b32 v49, v18, v17, 16
    v_alignbit_b32 v50, v19, v18, 16
    v_alignbit_b32 v51, v20, v19, 16
    s_waitcnt lgkmcnt(4)
    v_alignbit_b32 v52, v25, v24, 16
    v_alignbit_b32 v53, v26, v25, 16
    v_alignbit_b32 v54, v27, v26, 16
    v_alignbit_b32 v55, v28, v27, 16
    s_waitcnt lgkmcnt(2)
    v_alignbit_b32 v56, v33, v32, 16
    v_alignbit_b32 v57, v34, v33, 16
    v_alignbit_b32 v58, v35, v34, 16
    v_alignbit_b32 v59, v36, v35, 16
    s_waitcnt lgkmcnt(0)
    v_alignbit_b32 v60, v41, v40, 16
    v_alignbit_b32 v61, v42, v41, 16
    v_alignbit_b32 v62, v43, v42, 16
    v_alignbit_b32 v63, v44, v43, 16
    ds_write_b128 v2, v[48:51] offset:4160
    ds_write_b128 v2, v[52:55] offset:5184
    ds_write_b128 v2, v[56:59] offset:6208
    ds_write_b128 v2, v[60:63] offset:7232
    s_waitcnt lgkmcnt(0)
    s_lshl_b32 s7, s73, 2
    s_add_u32 s7, s7, 158548
    v_mov_b32 v1, s7
    v_mov_b32 v2, 1
    ds_write_b32 v1, v2
    s_branch L_cjoin_23
L_codd_22:
    v_lshlrev_b32 v1, 4, v0
    v_mov_b32 v16, 0
    v_mov_b32 v17, 0
    v_mov_b32 v18, 0
    v_mov_b32 v19, 0
    v_add_u32 v3, s70, v1
    s_mov_b64 exec, 0x3fffffff
    ds_write_b128 v3, v[16:19] offset:0
    s_mov_b64 exec, -1
L_cjoin_23:
    s_waitcnt lgkmcnt(0)
    s_cmp_eq_u32 s72, 0
    s_cbranch_scc1 L_cev_25
    s_cmp_lg_u32 s68, 1
    s_cbranch_scc1 L_k3w_26
    v_and_b32 v2, 15, v0
    v_lshlrev_b32 v2, 4, v2
    s_lshr_b32 s7, s2, 4
    v_add_u32 v2, s7, v2
    v_lshlrev_b32 v2, 7, v2
    v_add_u32 v2, 19529728, v2
    s_mov_b32 s99, 0
L_poll_28:
    global_load_dwordx2 v[6:7], v2, s[66:67] sc1
    s_add_u32 s99, s99, 1
    s_waitcnt vmcnt(0)
    v_cmp_ne_u32 vcc, v164, v6
    v_cmp_ne_u32 s[30:31], v165, v7
    s_or_b64 vcc, vcc, s[30:31]
    s_cmp_eq_u64 vcc, 0
    s_cbranch_scc1 L_pok_29
    s_cmp_gt_u32 s99, 200000
    s_cbranch_scc1 L_pok_29
    s_sleep 4
    s_branch L_poll_28
L_pok_29:
    v_mov_b32 v1, 158612
    v_mov_b32 v2, 1
    ds_write_b32 v1, v2
    s_branch L_k1d_27
L_k3w_26:
    v_mov_b32 v1, 158612
    s_mov_b32 s99, 0
L_spin_30:
    ds_read_b32 v3, v1
    s_add_u32 s99, s99, 1
    s_waitcnt lgkmcnt(0)
    v_readfirstlane_b32 s24, v3
    s_cmp_gt_u32 s99, 1000000
    s_cselect_b32 s24, 1, s24
    s_cmp_eq_u32 s24, 0
    s_cbranch_scc1 L_spin_30
L_k1d_27:
    s_lshl_b32 s26, s71, 12
    s_add_u32 s26, s26, 8388608
    v_lshlrev_b32 v1, 4, v0
    buffer_load_dwordx4 v[16:19], v1, s[8:11], s26 offen offset:0 sc1
    buffer_load_dwordx4 v[20:23], v1, s[8:11], s26 offen offset:1024 sc1
    buffer_load_dwordx4 v[24:27], v1, s[8:11], s26 offen offset:2048 sc1
    buffer_load_dwordx4 v[28:31], v1, s[8:11], s26 offen offset:3072 sc1
    v_add_u32 v3, s70, v1
    s_waitcnt vmcnt(3)
    ds_write_b128 v3, v[16:19] offset:480
    s_waitcnt vmcnt(2)
    ds_write_b128 v3, v[20:23] offset:1504
    s_waitcnt vmcnt(1)
    ds_write_b128 v3, v[24:27] offset:2528
    s_waitcnt vmcnt(0)
    ds_write_b128 v3, v[28:31] offset:3552
    s_waitcnt lgkmcnt(0)
    s_lshl_b32 s7, s73, 2
    s_add_u32 s7, s7, 158556
    v_mov_b32 v1, s7
    v_mov_b32 v2, 1
    ds_write_b32 v1, v2
L_cev_25:
    v_and_b32 v1, 15, v0
    v_lshrrev_b32 v2, 4, v0
    v_lshrrev_b32 v3, 1, v1
    v_lshlrev_b32 v6, 2, v2
    v_sub_u32 v6, v6, v3
    s_lshl_b32 s7, s72, 6
    s_sub_u32 s7, 839, s7
    v_add_u32 v6, s7, v6
    v_lshlrev_b32 v6, 2, v6
    v_and_b32 v3, 1, v1
    v_xor_b32 v3, 1, v3
    v_mul_u32_u24 v3, 4160, v3
    v_add_u32 v6, v6, v3
    s_add_u32 s7, s70, 4608
    v_add_u32 v8, s7, v6
    v_subrev_u32 v9, 1024, v8
    v_subrev_u32 v10, 2048, v8
    v_subrev_u32 v11, 3072, v8
    v_lshlrev_b32 v3, 5, v1
    v_lshlrev_b32 v6, 4, v2
    v_add_u32 v3, v3, v6
    s_lshl_b32 s7, s72, 8
    s_sub_u32 s7, 256, s7
    s_add_u32 s7, s7, s70
    v_add_u32 v12, s7, v3
    v_mov_b32 v16, 0
    v_mov_b32 v17, 0
    v_mov_b32 v18, 0
    v_mov_b32 v19, 0
    v_mov_b32 v20, 0
    v_mov_b32 v21, 0
    v_mov_b32 v22, 0
    v_mov_b32 v23, 0
    v_mov_b32 v24, 0
    v_mov_b32 v25, 0
    v_mov_b32 v26, 0
    v_mov_b32 v27, 0
    v_mov_b32 v28, 0
    v_mov_b32 v29, 0
    v_mov_b32 v30, 0
    v_mov_b32 v31, 0
    v_mov_b32 v32, 0
    v_mov_b32 v33, 0
    v_mov_b32 v34, 0
    v_mov_b32 v35, 0
    v_mov_b32 v36, 0
    v_mov_b32 v37, 0
    v_mov_b32 v38, 0
    v_mov_b32 v39, 0
    v_mov_b32 v40, 0
    v_mov_b32 v41, 0
    v_mov_b32 v42, 0
    v_mov_b32 v43, 0
    v_mov_b32 v44, 0
    v_mov_b32 v45, 0
    v_mov_b32 v46, 0
    v_mov_b32 v47, 0
    s_lshl_b32 s7, s73, 2
    s_add_u32 s26, s7, 158548
    s_add_u32 s27, s7, 158556
    v_mov_b32 v1, s26
    v_mov_b32 v2, s27
    s_mov_b32 s99, 0
L_spin_31:
    ds_read_b32 v3, v1
    ds_read_b32 v4, v2
    s_add_u32 s99, s99, 1
    s_waitcnt lgkmcnt(0)
    v_min_u32 v3, v3, v4
    s_nop 0
    v_readfirstlane_b32 s24, v3
    s_cmp_gt_u32 s99, 1000000
    s_cselect_b32 s24, 1, s24
    s_cmp_eq_u32 s24, 0
    s_cbranch_scc1 L_spin_31
    s_waitcnt vmcnt(0)
    v_lshlrev_b32 v5, 16, v151
    s_setprio 2
    ds_read_b128 v[112:115], v12 offset:192
    ds_read2_b32 v[48:49], v8 offset0:176 offset1:177
    ds_read2_b32 v[50:51], v8 offset0:178 offset1:179
    ds_read2_b32 v[52:53], v8 offset0:48 offset1:49
    ds_read2_b32 v[54:55], v8 offset0:50 offset1:51
    ds_read2_b32 v[56:57], v9 offset0:176 offset1:177
    ds_read2_b32 v[58:59], v9 offset0:178 offset1:179
    ds_read2_b32 v[60:61], v9 offset0:48 offset1:49
    ds_read2_b32 v[62:63], v9 offset0:50 offset1:51
    ds_read2_b32 v[64:65], v10 offset0:176 offset1:177
    ds_read2_b32 v[66:67], v10 offset0:178 offset1:179
    ds_read2_b32 v[68:69], v10 offset0:48 offset1:49
    ds_read2_b32 v[70:71], v10 offset0:50 offset1:51
    ds_read2_b32 v[72:73], v11 offset0:176 offset1:177
    ds_read2_b32 v[74:75], v11 offset0:178 offset1:179
    ds_read2_b32 v[76:77], v11 offset0:48 offset1:49
    ds_read2_b32 v[78:79], v11 offset0:50 offset1:51
    ds_read_b128 v[116:119], v12 offset:704
    ds_read_b128 v[120:123], v12 offset:1216
    ds_read_b128 v[124:127], v12 offset:1728
    ds_read_b128 v[128:131], v12 offset:2240
    ds_read_b128 v[132:135], v12 offset:2752
    ds_read_b128 v[136:139], v12 offset:3264
    ds_read_b128 v[140:143], v12 offset:3776
    s_waitcnt lgkmcnt(15)
    v_mfma_f32_16x16x32_bf16 v[16:19], v[48:51], v[112:115], v[16:19]
    ds_read2_b32 v[80:81], v8 offset0:160 offset1:161
    v_mfma_f32_16x16x32_bf16 v[20:23], v[52:55], v[112:115], v[20:23]
    ds_read2_b32 v[82:83], v8 offset0:162 offset1:163
    v_mfma_f32_16x16x32_bf16 v[24:27], v[56:59], v[112:115], v[24:27]
    ds_read2_b32 v[84:85], v8 offset0:32 offset1:33
    v_mfma_f32_16x16x32_bf16 v[28:31], v[60:63], v[112:115], v[28:31]
    ds_read2_b32 v[86:87], v8 offset0:34 offset1:35
    s_waitcnt lgkmcnt(15)
    v_mfma_f32_16x16x32_bf16 v[32:35], v[64:67], v[112:115], v[32:35]
    ds_read2_b32 v[88:89], v9 offset0:160 offset1:161
    v_mfma_f32_16x16x32_bf16 v[36:39], v[68:71], v[112:115], v[36:39]
    ds_read2_b32 v[90:91], v9 offset0:162 offset1:163
    s_waitcnt lgkmcnt(15)
    v_mfma_f32_16x16x32_bf16 v[40:43], v[72:75], v[112:115], v[40:43]
    ds_read2_b32 v[92:93], v9 offset0:32 offset1:33
    s_waitcnt lgkmcnt(14)
    v_mfma_f32_16x16x32_bf16 v[44:47], v[76:79], v[112:115], v[44:47]
    ds_read2_b32 v[94:95], v9 offset0:34 offset1:35
    ds_read_b128 v[112:115], v12 offset:128
    s_waitcnt lgkmcnt(15)
    v_mfma_f32_16x16x32_bf16 v[20:23], v[48:51], v[116:119], v[20:23]
    ds_read2_b32 v[96:97], v10 offset0:160 offset1:161
    v_mfma_f32_16x16x32_bf16 v[24:27], v[52:55], v[116:119], v[24:27]
    ds_read2_b32 v[98:99], v10 offset0:162 offset1:163
    v_mfma_f32_16x16x32_bf16 v[28:31], v[56:59], v[116:119], v[28:31]
    ds_read2_b32 v[100:101], v10 offset0:32 offset1:33
    v_mfma_f32_16x16x32_bf16 v[32:35], v[60:63], v[116:119], v[32:35]
    ds_read2_b32 v[102:103], v10 offset0:34 offset1:35
    v_mfma_f32_16x16x32_bf16 v[36:39], v[64:67], v[116:119], v[36:39]
    ds_read2_b32 v[104:105], v11 offset0:160 offset1:161
    v_mfma_f32_16x16x32_bf16 v[40:43], v[68:71], v[116:119], v[40:43]
    ds_read2_b32 v[106:107], v11 offset0:162 offset1:163
    v_mfma_f32_16x16x32_bf16 v[44:47], v[72:75], v[116:119], v[44:47]
    ds_read2_b32 v[108:109], v11 offset0:32 offset1:33
    ds_read_b128 v[116:119], v12 offset:640
    s_waitcnt lgkmcnt(15)
    v_mfma_f32_16x16x32_bf16 v[24:27], v[48:51], v[120:123], v[24:27]
    ds_read2_b32 v[110:111], v11 offset0:34 offset1:35
    v_mfma_f32_16x16x32_bf16 v[28:31], v[52:55], v[120:123], v[28:31]
    v_mfma_f32_16x16x32_bf16 v[32:35], v[56:59], v[120:123], v[32:35]
    v_mfma_f32_16x16x32_bf16 v[36:39], v[60:63], v[120:123], v[36:39]
    v_mfma_f32_16x16x32_bf16 v[40:43], v[64:67], v[120:123], v[40:43]
    v_mfma_f32_16x16x32_bf16 v[44:47], v[68:71], v[120:123], v[44:47]
    ds_read_b128 v[120:123], v12 offset:1152
    v_mfma_f32_16x16x32_bf16 v[28:31], v[48:51], v[124:127], v[28:31]
    v_mfma_f32_16x16x32_bf16 v[32:35], v[52:55], v[124:127], v[32:35]
    v_mfma_f32_16x16x32_bf16 v[36:39], v[56:59], v[124:127], v[36:39]
    v_mfma_f32_16x16x32_bf16 v[40:43], v[60:63], v[124:127], v[40:43]
    v_mfma_f32_16x16x32_bf16 v[44:47], v[64:67], v[124:127], v[44:47]
    ds_read_b128 v[124:127], v12 offset:1664
    v_mfma_f32_16x16x32_bf16 v[32:35], v[48:51], v[128:131], v[32:35]
    v_mfma_f32_16x16x32_bf16 v[36:39], v[52:55], v[128:131], v[36:39]
    v_mfma_f32_16x16x32_bf16 v[40:43], v[56:59], v[128:131], v[40:43]
    v_mfma_f32_16x16x32_bf16 v[44:47], v[60:63], v[128:131], v[44:47]
    ds_read_b128 v[128:131], v12 offset:2176
    v_mfma_f32_16x16x32_bf16 v[36:39], v[48:51], v[132:135], v[36:39]
    v_mfma_f32_16x16x32_bf16 v[40:43], v[52:55], v[132:135], v[40:43]
    v_mfma_f32_16x16x32_bf16 v[44:47], v[56:59], v[132:135], v[44:47]
    ds_read_b128 v[132:135], v12 offset:2688
    v_mfma_f32_16x16x32_bf16 v[40:43], v[48:51], v[136:139], v[40:43]
    v_mfma_f32_16x16x32_bf16 v[44:47], v[52:55], v[136:139], v[44:47]
    ds_read_b128 v[136:139], v12 offset:3200
    v_mfma_f32_16x16x32_bf16 v[44:47], v[48:51], v[140:143], v[44:47]
    ds_read_b128 v[140:143], v12 offset:3712
    s_waitcnt lgkmcnt(15)
    v_mfma_f32_16x16x32_bf16 v[16:19], v[80:83], v[112:115], v[16:19]
    ds_read2_b32 v[48:49], v8 offset0:144 offset1:145
    v_mfma_f32_16x16x32_bf16 v[20:23], v[84:87], v[112:115], v[20:23]
    ds_read2_b32 v[50:51], v8 offset0:146 offset1:147
    v_mfma_f32_16x16x32_bf16 v[24:27], v[88:91], v[112:115], v[24:27]
    ds_read2_b32 v[52:53], v8 offset0:16 offset1:17
    v_mfma_f32_16x16x32_bf16 v[28:31], v[92:95], v[112:115], v[28:31]
    ds_read2_b32 v[54:55], v8 offset0:18 offset1:19
    s_waitcnt lgkmcnt(15)
    v_mfma_f32_16x16x32_bf16 v[32:35], v[96:99], v[112:115], v[32:35]
    ds_read2_b32 v[56:57], v9 offset0:144 offset1:145
    v_mfma_f32_16x16x32_bf16 v[36:39], v[100:103], v[112:115], v[36:39]
    ds_read2_b32 v[58:59], v9 offset0:146 offset1:147
    s_waitcnt lgkmcnt(15)
    v_mfma_f32_16x16x32_bf16 v[40:43], v[104:107], v[112:115], v[40:43]
    ds_read2_b32 v[60:61], v9 offset0:16 offset1:17
    s_waitcnt lgkmcnt(13)
    v_mfma_f32_16x16x32_bf16 v[44:47], v[108:111], v[112:115], v[44:47]
    ds_read2_b32 v[62:63], v9 offset0:18 offset1:19
    ds_read_b128 v[112:115], v12 offset:64
    v_mfma_f32_16x16x32_bf16 v[20:23], v[80:83], v[116:119], v[20:23]
    ds_read2_b32 v[64:65], v10 offset0:144 offset1:145
    v_mfma_f32_16x16x32_bf16 v[24:27], v[84:87], v[116:119], v[24:27]
    ds_read2_b32 v[66:67], v10 offset0:146 offset1:147
    v_mfma_f32_16x16x32_bf16 v[28:31], v[88:91], v[116:119], v[28:31]
    ds_read2_b32 v[68:69], v10 offset0:16 offset1:17
    v_mfma_f32_16x16x32_bf16 v[32:35], v[92:95], v[116:119], v[32:35]
    ds_read2_b32 v[70:71], v10 offset0:18 offset1:19
    v_mfma_f32_16x16x32_bf16 v[36:39], v[96:99], v[116:119], v[36:39]
    ds_read2_b32 v[72:73], v11 offset0:144 offset1:145
    v_mfma_f32_16x16x32_bf16 v[40:43], v[100:103], v[116:119], v[40:43]
    ds_read2_b32 v[74:75], v11 offset0:146 offset1:147
    v_mfma_f32_16x16x32_bf16 v[44:47], v[104:107], v[116:119], v[44:47]
    ds_read2_b32 v[76:77], v11 offset0:16 offset1:17
    ds_read_b128 v[116:119], v12 offset:576
    s_waitcnt lgkmcnt(15)
    v_mfma_f32_16x16x32_bf16 v[24:27], v[80:83], v[120:123], v[24:27]
    ds_read2_b32 v[78:79], v11 offset0:18 offset1:19
    v_mfma_f32_16x16x32_bf16 v[28:31], v[84:87], v[120:123], v[28:31]
    v_mfma_f32_16x16x32_bf16 v[32:35], v[88:91], v[120:123], v[32:35]
    v_mfma_f32_16x16x32_bf16 v[36:39], v[92:95], v[120:123], v[36:39]
    v_mfma_f32_16x16x32_bf16 v[40:43], v[96:99], v[120:123], v[40:43]
    v_mfma_f32_16x16x32_bf16 v[44:47], v[100:103], v[120:123], v[44:47]
    ds_read_b128 v[120:123], v12 offset:1088
    v_mfma_f32_16x16x32_bf16 v[28:31], v[80:83], v[124:127], v[28:31]
    v_mfma_f32_16x16x32_bf16 v[32:35], v[84:87], v[124:127], v[32:35]
    v_mfma_f32_16x16x32_bf16 v[36:39], v[88:91], v[124:127], v[36:39]
    v_mfma_f32_16x16x32_bf16 v[40:43], v[92:95], v[124:127], v[40:43]
    v_mfma_f32_16x16x32_bf16 v[44:47], v[96:99], v[124:127], v[44:47]
    ds_read_b128 v[124:127], v12 offset:1600
    v_mfma_f32_16x16x32_bf16 v[32:35], v[80:83], v[128:131], v[32:35]
    v_mfma_f32_16x16x32_bf16 v[36:39], v[84:87], v[128:131], v[36:39]
    v_mfma_f32_16x16x32_bf16 v[40:43], v[88:91], v[128:131], v[40:43]
    v_mfma_f32_16x16x32_bf16 v[44:47], v[92:95], v[128:131], v[44:47]
    ds_read_b128 v[128:131], v12 offset:2112
    v_mfma_f32_16x16x32_bf16 v[36:39], v[80:83], v[132:135], v[36:39]
    v_mfma_f32_16x16x32_bf16 v[40:43], v[84:87], v[132:135], v[40:43]
    v_mfma_f32_16x16x32_bf16 v[44:47], v[88:91], v[132:135], v[44:47]
    ds_read_b128 v[132:135], v12 offset:2624
    v_mfma_f32_16x16x32_bf16 v[40:43], v[80:83], v[136:139], v[40:43]
    v_mfma_f32_16x16x32_bf16 v[44:47], v[84:87], v[136:139], v[44:47]
    ds_read_b128 v[136:139], v12 offset:3136
    v_mfma_f32_16x16x32_bf16 v[44:47], v[80:83], v[140:143], v[44:47]
    ds_read_b128 v[140:143], v12 offset:3648
    s_waitcnt lgkmcnt(15)
    v_mfma_f32_16x16x32_bf16 v[16:19], v[48:51], v[112:115], v[16:19]
    ds_read2_b32 v[80:81], v8 offset0:128 offset1:129
    v_mfma_f32_16x16x32_bf16 v[20:23], v[52:55], v[112:115], v[20:23]
    ds_read2_b32 v[82:83], v8 offset0:130 offset1:131
    v_mfma_f32_16x16x32_bf16 v[24:27], v[56:59], v[112:115], v[24:27]
    ds_read2_b32 v[84:85], v8 offset0:0 offset1:1
    v_mfma_f32_16x16x32_bf16 v[28:31], v[60:63], v[112:115], v[28:31]
    ds_read2_b32 v[86:87], v8 offset0:2 offset1:3
    s_waitcnt lgkmcnt(15)
    v_mfma_f32_16x16x32_bf16 v[32:35], v[64:67], v[112:115], v[32:35]
    ds_read2_b32 v[88:89], v9 offset0:128 offset1:129
    v_mfma_f32_16x16x32_bf16 v[36:39], v[68:71], v[112:115], v[36:39]
    ds_read2_b32 v[90:91], v9 offset0:130 offset1:131
    s_waitcnt lgkmcnt(15)
    v_mfma_f32_16x16x32_bf16 v[40:43], v[72:75], v[112:115], v[40:43]
    ds_read2_b32 v[92:93], v9 offset0:0 offset1:1
    s_waitcnt lgkmcnt(13)
    v_mfma_f32_16x16x32_bf16 v[44:47], v[76:79], v[112:115], v[44:47]
    ds_read2_b32 v[94:95], v9 offset0:2 offset1:3
    ds_read_b128 v[112:115], v12 offset:0
    v_mfma_f32_16x16x32_bf16 v[20:23], v[48:51], v[116:119], v[20:23]
    ds_read2_b32 v[96:97], v10 offset0:128 offset1:129
    v_mfma_f32_16x16x32_bf16 v[24:27], v[52:55], v[116:119], v[24:27]
    ds_read2_b32 v[98:99], v10 offset0:130 offset1:131
    v_mfma_f32_16x16x32_bf16 v[28:31], v[56:59], v[116:119], v[28:31]
    ds_read2_b32 v[100:101], v10 offset0:0 offset1:1
    v_mfma_f32_16x16x32_bf16 v[32:35], v[60:63], v[116:119], v[32:35]
    ds_read2_b32 v[102:103], v10 offset0:2 offset1:3
    v_mfma_f32_16x16x32_bf16 v[36:39], v[64:67], v[116:119], v[36:39]
    ds_read2_b32 v[104:105], v11 offset0:128 offset1:129
    v_mfma_f32_16x16x32_bf16 v[40:43], v[68:71], v[116:119], v[40:43]
    ds_read2_b32 v[106:107], v11 offset0:130 offset1:131
    v_mfma_f32_16x16x32_bf16 v[44:47], v[72:75], v[116:119], v[44:47]
    ds_read2_b32 v[108:109], v11 offset0:0 offset1:1
    ds_read_b128 v[116:119], v12 offset:512
    s_waitcnt lgkmcnt(15)
    v_mfma_f32_16x16x32_bf16 v[24:27], v[48:51], v[120:123], v[24:27]
    ds_read2_b32 v[110:111], v11 offset0:2 offset1:3
    v_mfma_f32_16x16x32_bf16 v[28:31], v[52:55], v[120:123], v[28:31]
    v_mfma_f32_16x16x32_bf16 v[32:35], v[56:59], v[120:123], v[32:35]
    v_mfma_f32_16x16x32_bf16 v[36:39], v[60:63], v[120:123], v[36:39]
    v_mfma_f32_16x16x32_bf16 v[40:43], v[64:67], v[120:123], v[40:43]
    v_mfma_f32_16x16x32_bf16 v[44:47], v[68:71], v[120:123], v[44:47]
    ds_read_b128 v[120:123], v12 offset:1024
    v_mfma_f32_16x16x32_bf16 v[28:31], v[48:51], v[124:127], v[28:31]
    v_mfma_f32_16x16x32_bf16 v[32:35], v[52:55], v[124:127], v[32:35]
    v_mfma_f32_16x16x32_bf16 v[36:39], v[56:59], v[124:127], v[36:39]
    v_mfma_f32_16x16x32_bf16 v[40:43], v[60:63], v[124:127], v[40:43]
    v_mfma_f32_16x16x32_bf16 v[44:47], v[64:67], v[124:127], v[44:47]
    ds_read_b128 v[124:127], v12 offset:1536
    v_mfma_f32_16x16x32_bf16 v[32:35], v[48:51], v[128:131], v[32:35]
    v_mfma_f32_16x16x32_bf16 v[36:39], v[52:55], v[128:131], v[36:39]
    v_mfma_f32_16x16x32_bf16 v[40:43], v[56:59], v[128:131], v[40:43]
    v_mfma_f32_16x16x32_bf16 v[44:47], v[60:63], v[128:131], v[44:47]
    ds_read_b128 v[128:131], v12 offset:2048
    v_mfma_f32_16x16x32_bf16 v[36:39], v[48:51], v[132:135], v[36:39]
    v_mfma_f32_16x16x32_bf16 v[40:43], v[52:55], v[132:135], v[40:43]
    v_mfma_f32_16x16x32_bf16 v[44:47], v[56:59], v[132:135], v[44:47]
    ds_read_b128 v[132:135], v12 offset:2560
    v_mfma_f32_16x16x32_bf16 v[40:43], v[48:51], v[136:139], v[40:43]
    v_mfma_f32_16x16x32_bf16 v[44:47], v[52:55], v[136:139], v[44:47]
    ds_read_b128 v[136:139], v12 offset:3072
    v_mfma_f32_16x16x32_bf16 v[44:47], v[48:51], v[140:143], v[44:47]
    ds_read_b128 v[140:143], v12 offset:3584
    s_waitcnt lgkmcnt(15)
    v_mfma_f32_16x16x32_bf16 v[16:19], v[80:83], v[112:115], v[16:19]
    v_mfma_f32_16x16x32_bf16 v[20:23], v[84:87], v[112:115], v[20:23]
    v_mfma_f32_16x16x32_bf16 v[24:27], v[88:91], v[112:115], v[24:27]
    v_mfma_f32_16x16x32_bf16 v[28:31], v[92:95], v[112:115], v[28:31]
    s_waitcnt lgkmcnt(13)
    v_mfma_f32_16x16x32_bf16 v[32:35], v[96:99], v[112:115], v[32:35]
    s_waitcnt lgkmcnt(11)
    v_mfma_f32_16x16x32_bf16 v[36:39], v[100:103], v[112:115], v[36:39]
    s_waitcnt lgkmcnt(9)
    v_mfma_f32_16x16x32_bf16 v[40:43], v[104:107], v[112:115], v[40:43]
    s_waitcnt lgkmcnt(6)
    v_mfma_f32_16x16x32_bf16 v[44:47], v[108:111], v[112:115], v[44:47]
    v_mfma_f32_16x16x32_bf16 v[20:23], v[80:83], v[116:119], v[20:23]
    v_mfma_f32_16x16x32_bf16 v[24:27], v[84:87], v[116:119], v[24:27]
    v_mfma_f32_16x16x32_bf16 v[28:31], v[88:91], v[116:119], v[28:31]
    v_mfma_f32_16x16x32_bf16 v[32:35], v[92:95], v[116:119], v[32:35]
    v_mfma_f32_16x16x32_bf16 v[36:39], v[96:99], v[116:119], v[36:39]
    v_mfma_f32_16x16x32_bf16 v[40:43], v[100:103], v[116:119], v[40:43]
    v_mfma_f32_16x16x32_bf16 v[44:47], v[104:107], v[116:119], v[44:47]
    s_waitcnt lgkmcnt(5)
    v_mfma_f32_16x16x32_bf16 v[24:27], v[80:83], v[120:123], v[24:27]
    v_mfma_f32_16x16x32_bf16 v[28:31], v[84:87], v[120:123], v[28:31]
    v_mfma_f32_16x16x32_bf16 v[32:35], v[88:91], v[120:123], v[32:35]
    v_mfma_f32_16x16x32_bf16 v[36:39], v[92:95], v[120:123], v[36:39]
    v_mfma_f32_16x16x32_bf16 v[40:43], v[96:99], v[120:123], v[40:43]
    v_mfma_f32_16x16x32_bf16 v[44:47], v[100:103], v[120:123], v[44:47]
    s_waitcnt lgkmcnt(4)
    v_mfma_f32_16x16x32_bf16 v[28:31], v[80:83], v[124:127], v[28:31]
    v_mfma_f32_16x16x32_bf16 v[32:35], v[84:87], v[124:127], v[32:35]
    v_mfma_f32_16x16x32_bf16 v[36:39], v[88:91], v[124:127], v[36:39]
    v_mfma_f32_16x16x32_bf16 v[40:43], v[92:95], v[124:127], v[40:43]
    v_mfma_f32_16x16x32_bf16 v[44:47], v[96:99], v[124:127], v[44:47]
    s_waitcnt lgkmcnt(3)
    v_mfma_f32_16x16x32_bf16 v[32:35], v[80:83], v[128:131], v[32:35]
    v_mfma_f32_16x16x32_bf16 v[36:39], v[84:87], v[128:131], v[36:39]
    v_mfma_f32_16x16x32_bf16 v[40:43], v[88:91], v[128:131], v[40:43]
    v_mfma_f32_16x16x32_bf16 v[44:47], v[92:95], v[128:131], v[44:47]
    s_waitcnt lgkmcnt(2)
    v_mfma_f32_16x16x32_bf16 v[36:39], v[80:83], v[132:135], v[36:39]
    v_mfma_f32_16x16x32_bf16 v[40:43], v[84:87], v[132:135], v[40:43]
    v_mfma_f32_16x16x32_bf16 v[44:47], v[88:91], v[132:135], v[44:47]
    s_waitcnt lgkmcnt(1)
    v_mfma_f32_16x16x32_bf16 v[40:43], v[80:83], v[136:139], v[40:43]
    v_mfma_f32_16x16x32_bf16 v[44:47], v[84:87], v[136:139], v[44:47]
    s_waitcnt lgkmcnt(0)
    v_mfma_f32_16x16x32_bf16 v[44:47], v[80:83], v[140:143], v[44:47]
    s_setprio 2
    v_lshlrev_b32 v13, 4, v0
    s_lshl_b32 s7, s68, 12
    s_add_u32 s7, s7, 25856
    v_add_u32 v3, s7, v13
    s_cmp_eq_u32 s72, 0
    s_nop 4
    s_cbranch_scc1 L_ex0_32
    ds_write_b128 v3, v[16:19] offset:0
    ds_write_b128 v3, v[20:23] offset:1024
    ds_write_b128 v3, v[24:27] offset:2048
    ds_write_b128 v3, v[28:31] offset:3072
    v_mov_b32 v16, v32
    v_mov_b32 v17, v33
    v_mov_b32 v18, v34
    v_mov_b32 v19, v35
    v_mov_b32 v20, v36
    v_mov_b32 v21, v37
    v_mov_b32 v22, v38
    v_mov_b32 v23, v39
    v_mov_b32 v24, v40
    v_mov_b32 v25, v41
    v_mov_b32 v26, v42
    v_mov_b32 v27, v43
    v_mov_b32 v28, v44
    v_mov_b32 v29, v45
    v_mov_b32 v30, v46
    v_mov_b32 v31, v47
    s_branch L_exd_33
L_ex0_32:
    ds_write_b128 v3, v[32:35] offset:0
    ds_write_b128 v3, v[36:39] offset:1024
    ds_write_b128 v3, v[40:43] offset:2048
    ds_write_b128 v3, v[44:47] offset:3072
L_exd_33:
    s_waitcnt lgkmcnt(0)
    s_lshl_b32 s7, s68, 2
    s_add_u32 s7, s7, 158564
    v_mov_b32 v1, s7
    v_mov_b32 v2, 1
    ds_write_b32 v1, v2
    s_xor_b32 s7, s68, 1
    s_lshl_b32 s26, s7, 2
    s_add_u32 s26, s26, 158564
    s_lshl_b32 s27, s7, 12
    s_add_u32 s27, s27, 25856
    v_add_u32 v14, s27, v13
    v_mov_b32 v1, s26
    s_mov_b32 s99, 0
L_spin_34:
    ds_read_b32 v3, v1
    s_add_u32 s99, s99, 1
    s_waitcnt lgkmcnt(0)
    v_readfirstlane_b32 s24, v3
    s_cmp_gt_u32 s99, 1000000
    s_cselect_b32 s24, 1, s24
    s_cmp_eq_u32 s24, 0
    s_cbranch_scc1 L_spin_34
    ds_read_b128 v[32:35], v14 offset:0
    ds_read_b128 v[36:39], v14 offset:1024
    ds_read_b128 v[40:43], v14 offset:2048
    ds_read_b128 v[44:47], v14 offset:3072
    v_and_b32 v1, 15, v0
    v_lshlrev_b32 v1, 5, v1
    v_lshrrev_b32 v2, 4, v0
    v_lshlrev_b32 v2, 3, v2
    v_add_u32 v1, v1, v2
    s_lshl_b32 s7, s72, 11
    s_add_u32 s24, s7, s70
    v_add_u32 v2, s24, v1
    ds_read_b64 v[48:49], v2 offset:480
    ds_read_b64 v[50:51], v2 offset:992
    ds_read_b64 v[52:53], v2 offset:1504
    ds_read_b64 v[54:55], v2 offset:2016
    s_lshl_b32 s24, s71, 12
    s_add_u32 s24, s24, 13631488
    s_lshl_b32 s7, s72, 11
    s_add_u32 s24, s24, s7
    s_waitcnt lgkmcnt(0)
    v_add_f32 v16, v16, v32
    v_add_f32 v17, v17, v33
    v_add_f32 v18, v18, v34
    v_add_f32 v19, v19, v35
    v_cvt_pk_bf16_f32 v64, v16, v17
    v_cvt_pk_bf16_f32 v65, v18, v19
    v_lshlrev_b32 v66, 16, v48
    v_and_b32 v67, 0xffff0000, v48
    v_lshlrev_b32 v68, 16, v49
    v_and_b32 v69, 0xffff0000, v49
    v_mul_f32 v66, v66, v5
    v_mul_f32 v67, v67, v5
    v_mul_f32 v68, v68, v5
    v_mul_f32 v69, v69, v5
    v_cvt_pk_bf16_f32 v70, v66, v67
    v_cvt_pk_bf16_f32 v71, v68, v69
    v_lshlrev_b32 v66, 16, v70
    v_and_b32 v67, 0xffff0000, v70
    v_lshlrev_b32 v72, 16, v64
    v_and_b32 v73, 0xffff0000, v64
    v_lshlrev_b32 v68, 16, v71
    v_and_b32 v69, 0xffff0000, v71
    v_lshlrev_b32 v74, 16, v65
    v_and_b32 v75, 0xffff0000, v65
    v_add_f32 v66, v66, v72
    v_add_f32 v67, v67, v73
    v_add_f32 v68, v68, v74
    v_add_f32 v69, v69, v75
    v_cvt_pk_bf16_f32 v80, v66, v67
    v_cvt_pk_bf16_f32 v81, v68, v69
    buffer_store_dwordx2 v[80:81], v1, s[8:11], s24 offen offset:0 sc1
    v_add_f32 v20, v20, v36
    v_add_f32 v21, v21, v37
    v_add_f32 v22, v22, v38
    v_add_f32 v23, v23, v39
    v_cvt_pk_bf16_f32 v64, v20, v21
    v_cvt_pk_bf16_f32 v65, v22, v23
    v_lshlrev_b32 v66, 16, v50
    v_and_b32 v67, 0xffff0000, v50
    v_lshlrev_b32 v68, 16, v51
    v_and_b32 v69, 0xffff0000, v51
    v_mul_f32 v66, v66, v5
    v_mul_f32 v67, v67, v5
    v_mul_f32 v68, v68, v5
    v_mul_f32 v69, v69, v5
    v_cvt_pk_bf16_f32 v70, v66, v67
    v_cvt_pk_bf16_f32 v71, v68, v69
    v_lshlrev_b32 v66, 16, v70
    v_and_b32 v67, 0xffff0000, v70
    v_lshlrev_b32 v72, 16, v64
    v_and_b32 v73, 0xffff0000, v64
    v_lshlrev_b32 v68, 16, v71
    v_and_b32 v69, 0xffff0000, v71
    v_lshlrev_b32 v74, 16, v65
    v_and_b32 v75, 0xffff0000, v65
    v_add_f32 v66, v66, v72
    v_add_f32 v67, v67, v73
    v_add_f32 v68, v68, v74
    v_add_f32 v69, v69, v75
    v_cvt_pk_bf16_f32 v84, v66, v67
    v_cvt_pk_bf16_f32 v85, v68, v69
    buffer_store_dwordx2 v[84:85], v1, s[8:11], s24 offen offset:512 sc1
    v_add_f32 v24, v24, v40
    v_add_f32 v25, v25, v41
    v_add_f32 v26, v26, v42
    v_add_f32 v27, v27, v43
    v_cvt_pk_bf16_f32 v64, v24, v25
    v_cvt_pk_bf16_f32 v65, v26, v27
    v_lshlrev_b32 v66, 16, v52
    v_and_b32 v67, 0xffff0000, v52
    v_lshlrev_b32 v68, 16, v53
    v_and_b32 v69, 0xffff0000, v53
    v_mul_f32 v66, v66, v5
    v_mul_f32 v67, v67, v5
    v_mul_f32 v68, v68, v5
    v_mul_f32 v69, v69, v5
    v_cvt_pk_bf16_f32 v70, v66, v67
    v_cvt_pk_bf16_f32 v71, v68, v69
    v_lshlrev_b32 v66, 16, v70
    v_and_b32 v67, 0xffff0000, v70
    v_lshlrev_b32 v72, 16, v64
    v_and_b32 v73, 0xffff0000, v64
    v_lshlrev_b32 v68, 16, v71
    v_and_b32 v69, 0xffff0000, v71
    v_lshlrev_b32 v74, 16, v65
    v_and_b32 v75, 0xffff0000, v65
    v_add_f32 v66, v66, v72
    v_add_f32 v67, v67, v73
    v_add_f32 v68, v68, v74
    v_add_f32 v69, v69, v75
    v_cvt_pk_bf16_f32 v88, v66, v67
    v_cvt_pk_bf16_f32 v89, v68, v69
    buffer_store_dwordx2 v[88:89], v1, s[8:11], s24 offen offset:1024 sc1
    v_add_f32 v28, v28, v44
    v_add_f32 v29, v29, v45
    v_add_f32 v30, v30, v46
    v_add_f32 v31, v31, v47
    v_cvt_pk_bf16_f32 v64, v28, v29
    v_cvt_pk_bf16_f32 v65, v30, v31
    v_lshlrev_b32 v66, 16, v54
    v_and_b32 v67, 0xffff0000, v54
    v_lshlrev_b32 v68, 16, v55
    v_and_b32 v69, 0xffff0000, v55
    v_mul_f32 v66, v66, v5
    v_mul_f32 v67, v67, v5
    v_mul_f32 v68, v68, v5
    v_mul_f32 v69, v69, v5
    v_cvt_pk_bf16_f32 v70, v66, v67
    v_cvt_pk_bf16_f32 v71, v68, v69
    v_lshlrev_b32 v66, 16, v70
    v_and_b32 v67, 0xffff0000, v70
    v_lshlrev_b32 v72, 16, v64
    v_and_b32 v73, 0xffff0000, v64
    v_lshlrev_b32 v68, 16, v71
    v_and_b32 v69, 0xffff0000, v71
    v_lshlrev_b32 v74, 16, v65
    v_and_b32 v75, 0xffff0000, v65
    v_add_f32 v66, v66, v72
    v_add_f32 v67, v67, v73
    v_add_f32 v68, v68, v74
    v_add_f32 v69, v69, v75
    v_cvt_pk_bf16_f32 v92, v66, v67
    v_cvt_pk_bf16_f32 v93, v68, v69
    buffer_store_dwordx2 v[92:93], v1, s[8:11], s24 offen offset:1536 sc1
    s_waitcnt vmcnt(0)
    v_mov_b32 v1, 158608
    v_mov_b32 v2, 1
    s_mov_b64 exec, 1
    ds_add_rtn_u32 v3, v1, v2
    s_mov_b64 exec, -1
    s_waitcnt lgkmcnt(0)
    v_readfirstlane_b32 s7, v3
    s_cmp_lg_u32 s7, 3
    s_cbranch_scc1 L_nfy_35
    s_lshl_b32 s7, s2, 7
    s_add_u32 s7, s7, 19595264
    v_mov_b32 v1, s7
    s_mov_b64 exec, 1
    global_store_dwordx2 v1, v[164:165], s[66:67] sc1
    s_mov_b64 exec, -1
L_nfy_35:
    global_load_dwordx4 v[160:163], v166, s[36:37]
    s_waitcnt vmcnt(0)
    s_branch L_final_1
L_ld_5:
    s_sub_u32 s68, s3, 4
    v_lshrrev_b32 v6, 3, v0
    v_lshlrev_b32 v2, 10, v6
    v_and_b32 v6, 7, v0
    v_lshrrev_b32 v7, 4, v0
    v_xor_b32 v6, v6, v7
    v_lshlrev_b32 v6, 4, v6
    v_add_u32 v2, v2, v6
    v_xor_b32 v3, 64, v2
    v_lshrrev_b32 v6, 2, v0
    s_movk_i32 s29, 2752
    v_mul_lo_u32 v4, v6, s29
    v_and_b32 v6, 3, v0
    v_lshlrev_b32 v7, 4, v6
    v_xor_b32 v6, 2, v6
    v_lshlrev_b32 v6, 4, v6
    v_add_u32 v5, v4, v6
    v_add_u32 v4, v4, v7
    s_lshl_b32 s25, s4, 17
    s_lshl_b32 s29, s68, 15
    s_add_u32 s25, s25, s29
    s_mul_i32 s26, s68, 44032
    s_mul_i32 s29, s5, 192
    s_add_u32 s26, s26, s29
    s_lshl_b32 s27, s68, 12
    s_lshl_b32 s28, s68, 10
    s_add_u32 s28, s28, 16384
    s_mov_b32 s32, s6
    s_waitcnt lgkmcnt(0)
    s_mov_b32 s8, s36
    s_mov_b32 s9, s37
    s_mov_b32 s10, 2097152
    s_mov_b32 s11, 0x20000
    s_mov_b32 s12, s56
    s_mov_b32 s13, s57
    s_mov_b32 s14, 1409024
    s_mov_b32 s15, 0x20000
    s_mov_b32 s16, s58
    s_mov_b32 s17, s59
    s_mov_b32 s18, 1409024
    s_mov_b32 s19, 0x20000
    s_lshl_b32 s30, s32, 7
    s_add_u32 s30, s30, s25
    s_mul_i32 s31, s32, 176128
    s_add_u32 s31, s31, s26
    s_add_u32 s34, s27, 0
    s_add_u32 s35, s28, 0
    s_add_u32 s32, s32, 1
    s_and_b32 s32, s32, 7
    s_add_u32 m0, s34, 0
    s_add_u32 s29, s30, 0
    buffer_load_dwordx4 v2, s[8:11], s29 offen lds
    s_add_u32 m0, s35, 0
    s_add_u32 s29, s31, 0
    buffer_load_dwordx4 v4, s[12:15], s29 offen lds
    s_add_u32 m0, s35, 12288
    s_add_u32 s29, s31, 0
    buffer_load_dwordx4 v5, s[16:19], s29 offen lds
    s_add_u32 m0, s34, 1024
    s_add_u32 s29, s30, 8192
    buffer_load_dwordx4 v3, s[8:11], s29 offen lds
    s_add_u32 m0, s35, 4096
    s_add_u32 s29, s31, 64
    buffer_load_dwordx4 v4, s[12:15], s29 offen lds
    s_add_u32 m0, s35, 16384
    s_add_u32 s29, s31, 64
    buffer_load_dwordx4 v5, s[16:19], s29 offen lds
    s_add_u32 m0, s34, 2048
    s_add_u32 s29, s30, 16384
    buffer_load_dwordx4 v2, s[8:11], s29 offen lds
    s_add_u32 m0, s35, 8192
    s_add_u32 s29, s31, 128
    buffer_load_dwordx4 v4, s[12:15], s29 offen lds
    s_add_u32 m0, s35, 20480
    s_add_u32 s29, s31, 128
    buffer_load_dwordx4 v5, s[16:19], s29 offen lds
    s_add_u32 m0, s34, 3072
    s_add_u32 s29, s30, 24576
    buffer_load_dwordx4 v3, s[8:11], s29 offen lds
    s_lshl_b32 s30, s32, 7
    s_add_u32 s30, s30, s25
    s_mul_i32 s31, s32, 176128
    s_add_u32 s31, s31, s26
    s_add_u32 s34, s27, 40960
    s_add_u32 s35, s28, 40960
    s_add_u32 s32, s32, 1
    s_and_b32 s32, s32, 7
    s_add_u32 m0, s34, 0
    s_add_u32 s29, s30, 0
    buffer_load_dwordx4 v2, s[8:11], s29 offen lds
    s_add_u32 m0, s35, 0
    s_add_u32 s29, s31, 0
    buffer_load_dwordx4 v4, s[12:15], s29 offen lds
    s_add_u32 m0, s35, 12288
    s_add_u32 s29, s31, 0
    buffer_load_dwordx4 v5, s[16:19], s29 offen lds
    s_waitcnt vmcnt(3)
    s_barrier
    s_mov_b32 s33, 81920
    s_mov_b32 s7, 0
L_ldloop_36:
    s_add_u32 m0, s34, 1024
    s_add_u32 s29, s30, 8192
    buffer_load_dwordx4 v3, s[8:11], s29 offen lds
    s_add_u32 m0, s35, 4096
    s_add_u32 s29, s31, 64
    buffer_load_dwordx4 v4, s[12:15], s29 offen lds
    s_add_u32 m0, s35, 16384
    s_add_u32 s29, s31, 64
    buffer_load_dwordx4 v5, s[16:19], s29 offen lds
    s_add_u32 m0, s34, 2048
    s_add_u32 s29, s30, 16384
    buffer_load_dwordx4 v2, s[8:11], s29 offen lds
    s_add_u32 m0, s35, 8192
    s_add_u32 s29, s31, 128
    buffer_load_dwordx4 v4, s[12:15], s29 offen lds
    s_add_u32 m0, s35, 20480
    s_add_u32 s29, s31, 128
    buffer_load_dwordx4 v5, s[16:19], s29 offen lds
    s_add_u32 m0, s34, 3072
    s_add_u32 s29, s30, 24576
    buffer_load_dwordx4 v3, s[8:11], s29 offen lds
    s_lshl_b32 s30, s32, 7
    s_add_u32 s30, s30, s25
    s_mul_i32 s31, s32, 176128
    s_add_u32 s31, s31, s26
    s_add_u32 s34, s27, s33
    s_add_u32 s35, s28, s33
    s_add_u32 s32, s32, 1
    s_and_b32 s32, s32, 7
    s_add_u32 m0, s34, 0
    s_add_u32 s29, s30, 0
    buffer_load_dwordx4 v2, s[8:11], s29 offen lds
    s_add_u32 m0, s35, 0
    s_add_u32 s29, s31, 0
    buffer_load_dwordx4 v4, s[12:15], s29 offen lds
    s_add_u32 m0, s35, 12288
    s_add_u32 s29, s31, 0
    buffer_load_dwordx4 v5, s[16:19], s29 offen lds
    s_waitcnt vmcnt(3)
    s_barrier
    s_add_u32 s33, s33, 40960
    s_cmp_eq_u32 s33, 122880
    s_cselect_b32 s33, 0, s33
    s_add_u32 s7, s7, 1
    s_cmp_lt_u32 s7, 6
    s_cbranch_scc1 L_ldloop_36
    s_add_u32 m0, s34, 1024
    s_add_u32 s29, s30, 8192
    buffer_load_dwordx4 v3, s[8:11], s29 offen lds
    s_add_u32 m0, s35, 4096
    s_add_u32 s29, s31, 64
    buffer_load_dwordx4 v4, s[12:15], s29 offen lds
    s_add_u32 m0, s35, 16384
    s_add_u32 s29, s31, 64
    buffer_load_dwordx4 v5, s[16:19], s29 offen lds
    s_add_u32 m0, s34, 2048
    s_add_u32 s29, s30, 16384
    buffer_load_dwordx4 v2, s[8:11], s29 offen lds
    s_add_u32 m0, s35, 8192
    s_add_u32 s29, s31, 128
    buffer_load_dwordx4 v4, s[12:15], s29 offen lds
    s_add_u32 m0, s35, 20480
    s_add_u32 s29, s31, 128
    buffer_load_dwordx4 v5, s[16:19], s29 offen lds
    s_add_u32 m0, s34, 3072
    s_add_u32 s29, s30, 24576
    buffer_load_dwordx4 v3, s[8:11], s29 offen lds
    s_cmp_eq_u32 s68, 3
    s_cbranch_scc1 L_l0_37
    s_waitcnt vmcnt(0)
    s_barrier
    s_branch L_gemm2_7
L_l0_37:
    s_add_u32 s24, s66, 18939904
    s_addc_u32 s25, s67, 0
    s_mov_b32 s26, 262144
    s_mov_b32 s27, 0x20000
    v_mov_b32 v1, 158528
    ds_read_b64 v[152:153], v1
    v_lshlrev_b32 v8, 4, v0
    s_lshl_b32 s73, s5, 14
    buffer_load_dwordx4 v[16:19], v8, s[24:27], s73 offen offset:0 sc1
    buffer_load_dwordx4 v[20:23], v8, s[24:27], s73 offen offset:1024 sc1
    buffer_load_dwordx4 v[24:27], v8, s[24:27], s73 offen offset:2048 sc1
    buffer_load_dwordx4 v[28:31], v8, s[24:27], s73 offen offset:3072 sc1
    s_add_u32 s74, s73, 4096
    buffer_load_dwordx4 v[32:35], v8, s[24:27], s74 offen sc1
    s_add_u32 s74, s73, 5120
    buffer_load_dwordx4 v[36:39], v8, s[24:27], s74 offen sc1
    s_add_u32 s74, s73, 6144
    buffer_load_dwordx4 v[40:43], v8, s[24:27], s74 offen sc1
    s_add_u32 s74, s73, 7168
    buffer_load_dwordx4 v[44:47], v8, s[24:27], s74 offen sc1
    s_add_u32 s74, s73, 8192
    buffer_load_dwordx4 v[48:51], v8, s[24:27], s74 offen sc1
    s_add_u32 s74, s73, 9216
    buffer_load_dwordx4 v[52:55], v8, s[24:27], s74 offen sc1
    s_add_u32 s74, s73, 10240
    buffer_load_dwordx4 v[56:59], v8, s[24:27], s74 offen sc1
    s_add_u32 s74, s73, 11264
    buffer_load_dwordx4 v[60:63], v8, s[24:27], s74 offen sc1
    s_add_u32 s74, s73, 12288
    buffer_load_dwordx4 v[64:67], v8, s[24:27], s74 offen sc1
    s_add_u32 s74, s73, 13312
    buffer_load_dwordx4 v[68:71], v8, s[24:27], s74 offen sc1
    s_add_u32 s74, s73, 14336
    buffer_load_dwordx4 v[72:75], v8, s[24:27], s74 offen sc1
    s_add_u32 s74, s73, 15360
    buffer_load_dwordx4 v[76:79], v8, s[24:27], s74 offen sc1
    s_lshr_b32 s74, s2, 3
    s_mul_i32 s74, s74, 44032
    s_and_b32 s75, s2, 1
    s_lshl_b32 s75, s75, 9
    s_add_u32 s74, s74, s75
    v_lshrrev_b32 v9, 2, v0
    v_lshlrev_b32 v9, 10, v9
    v_and_b32 v10, 3, v0
    v_lshlrev_b32 v10, 7, v10
    v_add_u32 v9, v9, v10
    v_add_u32 v9, s74, v9
    s_mov_b32 s8, s60
    s_mov_b32 s9, s61
    s_mov_b32 s10, 1409024
    s_mov_b32 s11, 0x20000
    s_mov_b32 s74, 0
    buffer_load_dword v144, v9, s[8:11], s74 offen
    s_mov_b32 s74, 16384
    buffer_load_dword v145, v9, s[8:11], s74 offen
    s_mov_b32 s74, 32768
    buffer_load_dword v146, v9, s[8:11], s74 offen
    s_waitcnt vmcnt(19)
    s_barrier
    s_setprio 3
    s_mov_b32 s75, 0
    s_waitcnt vmcnt(3)
    s_waitcnt lgkmcnt(0)
L_gchk_38:
    s_mov_b64 vcc, 0
    v_cmp_ne_u32 s[32:33], v152, v19
    s_or_b64 vcc, vcc, s[32:33]
    v_cmp_ne_u32 s[32:33], v152, v23
    s_or_b64 vcc, vcc, s[32:33]
    v_cmp_ne_u32 s[32:33], v152, v27
    s_or_b64 vcc, vcc, s[32:33]
    v_cmp_ne_u32 s[32:33], v152, v31
    s_or_b64 vcc, vcc, s[32:33]
    v_cmp_ne_u32 s[32:33], v152, v35
    s_or_b64 vcc, vcc, s[32:33]
    v_cmp_ne_u32 s[32:33], v152, v39
    s_or_b64 vcc, vcc, s[32:33]
    v_cmp_ne_u32 s[32:33], v152, v43
    s_or_b64 vcc, vcc, s[32:33]
    v_cmp_ne_u32 s[32:33], v152, v47
    s_or_b64 vcc, vcc, s[32:33]
    v_cmp_ne_u32 s[32:33], v152, v51
    s_or_b64 vcc, vcc, s[32:33]
    v_cmp_ne_u32 s[32:33], v152, v55
    s_or_b64 vcc, vcc, s[32:33]
    v_cmp_ne_u32 s[32:33], v152, v59
    s_or_b64 vcc, vcc, s[32:33]
    v_cmp_ne_u32 s[32:33], v152, v63
    s_or_b64 vcc, vcc, s[32:33]
    v_cmp_ne_u32 s[32:33], v152, v67
    s_or_b64 vcc, vcc, s[32:33]
    v_cmp_ne_u32 s[32:33], v152, v71
    s_or_b64 vcc, vcc, s[32:33]
    v_cmp_ne_u32 s[32:33], v152, v75
    s_or_b64 vcc, vcc, s[32:33]
    v_cmp_ne_u32 s[32:33], v152, v79
    s_or_b64 vcc, vcc, s[32:33]
    s_add_u32 s75, s75, 1
    s_cmp_eq_u64 vcc, 0
    s_cbranch_scc1 L_gok_39
    s_cmp_gt_u32 s75, 100000
    s_cbranch_scc1 L_gok_39
    buffer_load_dwordx4 v[16:19], v8, s[24:27], s73 offen offset:0 sc1
    buffer_load_dwordx4 v[20:23], v8, s[24:27], s73 offen offset:1024 sc1
    buffer_load_dwordx4 v[24:27], v8, s[24:27], s73 offen offset:2048 sc1
    buffer_load_dwordx4 v[28:31], v8, s[24:27], s73 offen offset:3072 sc1
    s_add_u32 s74, s73, 4096
    buffer_load_dwordx4 v[32:35], v8, s[24:27], s74 offen sc1
    s_add_u32 s74, s73, 5120
    buffer_load_dwordx4 v[36:39], v8, s[24:27], s74 offen sc1
    s_add_u32 s74, s73, 6144
    buffer_load_dwordx4 v[40:43], v8, s[24:27], s74 offen sc1
    s_add_u32 s74, s73, 7168
    buffer_load_dwordx4 v[44:47], v8, s[24:27], s74 offen sc1
    s_add_u32 s74, s73, 8192
    buffer_load_dwordx4 v[48:51], v8, s[24:27], s74 offen sc1
    s_add_u32 s74, s73, 9216
    buffer_load_dwordx4 v[52:55], v8, s[24:27], s74 offen sc1
    s_add_u32 s74, s73, 10240
    buffer_load_dwordx4 v[56:59], v8, s[24:27], s74 offen sc1
    s_add_u32 s74, s73, 11264
    buffer_load_dwordx4 v[60:63], v8, s[24:27], s74 offen sc1
    s_add_u32 s74, s73, 12288
    buffer_load_dwordx4 v[64:67], v8, s[24:27], s74 offen sc1
    s_add_u32 s74, s73, 13312
    buffer_load_dwordx4 v[68:71], v8, s[24:27], s74 offen sc1
    s_add_u32 s74, s73, 14336
    buffer_load_dwordx4 v[72:75], v8, s[24:27], s74 offen sc1
    s_add_u32 s74, s73, 15360
    buffer_load_dwordx4 v[76:79], v8, s[24:27], s74 offen sc1
    s_waitcnt vmcnt(0)
    s_branch L_gchk_38
L_gok_39:
    v_add_f32 v16, v16, v48
    v_add_f32 v17, v17, v49
    v_add_f32 v18, v18, v50
    v_add_f32 v20, v20, v52
    v_add_f32 v21, v21, v53
    v_add_f32 v22, v22, v54
    v_add_f32 v24, v24, v56
    v_add_f32 v25, v25, v57
    v_add_f32 v26, v26, v58
    v_add_f32 v28, v28, v60
    v_add_f32 v29, v29, v61
    v_add_f32 v30, v30, v62
    v_add_f32 v32, v32, v64
    v_add_f32 v33, v33, v65
    v_add_f32 v34, v34, v66
    v_add_f32 v36, v36, v68
    v_add_f32 v37, v37, v69
    v_add_f32 v38, v38, v70
    v_add_f32 v40, v40, v72
    v_add_f32 v41, v41, v73
    v_add_f32 v42, v42, v74
    v_add_f32 v44, v44, v76
    v_add_f32 v45, v45, v77
    v_add_f32 v46, v46, v78
    v_add_f32 v16, v16, v32
    v_add_f32 v17, v17, v33
    v_add_f32 v18, v18, v34
    v_add_f32 v20, v20, v36
    v_add_f32 v21, v21, v37
    v_add_f32 v22, v22, v38
    v_add_f32 v24, v24, v40
    v_add_f32 v25, v25, v41
    v_add_f32 v26, v26, v42
    v_add_f32 v28, v28, v44
    v_add_f32 v29, v29, v45
    v_add_f32 v30, v30, v46
    v_add_f32 v16, v16, v24
    v_add_f32 v17, v17, v25
    v_add_f32 v18, v18, v26
    v_add_f32 v20, v20, v28
    v_add_f32 v21, v21, v29
    v_add_f32 v22, v22, v30
    v_add_f32 v16, v16, v20
    v_add_f32 v17, v17, v21
    v_add_f32 v18, v18, v22
    v_lshrrev_b32 v1, 3, v0
    v_mul_u32_u24 v1, 3, v1
    v_bfe_u32 v2, v0, 2, 1
    v_lshlrev_b32 v2, 4, v2
    v_and_b32 v3, 3, v0
    v_lshlrev_b32 v3, 2, v3
    v_add_u32 v2, v2, v3
    v_add_u32 v4, 0, v1
    v_lshrrev_b32 v5, 2, v4
    v_lshlrev_b32 v5, 5, v5
    v_and_b32 v4, 3, v4
    v_add_u32 v4, v4, v5
    v_add_u32 v4, v4, v2
    v_lshlrev_b32 v4, 2, v4
    v_add_u32 v4, 156672, v4
    ds_write_b32 v4, v16
    v_add_u32 v4, 1, v1
    v_lshrrev_b32 v5, 2, v4
    v_lshlrev_b32 v5, 5, v5
    v_and_b32 v4, 3, v4
    v_add_u32 v4, v4, v5
    v_add_u32 v4, v4, v2
    v_lshlrev_b32 v4, 2, v4
    v_add_u32 v4, 156672, v4
    ds_write_b32 v4, v17
    v_add_u32 v4, 2, v1
    v_lshrrev_b32 v5, 2, v4
    v_lshlrev_b32 v5, 5, v5
    v_and_b32 v4, 3, v4
    v_add_u32 v4, v4, v5
    v_add_u32 v4, v4, v2
    v_lshlrev_b32 v4, 2, v4
    v_add_u32 v4, 156672, v4
    ds_write_b32 v4, v18
    s_waitcnt lgkmcnt(0)
    v_mov_b32 v1, 158584
    v_mov_b32 v2, 1
    ds_write_b32 v1, v2
    s_setprio 0
    s_branch L_gemm2_7
L_g_4:
    s_setprio 3
    v_lshrrev_b32 v1, 5, v0
    v_lshlrev_b32 v1, 10, v1
    v_and_b32 v2, 31, v0
    v_lshlrev_b32 v2, 4, v2
    v_add_u32 v1, v1, v2
    s_lshl_b32 s7, s4, 4
    s_add_u32 s7, s7, s5
    s_lshl_b32 s7, s7, 3
    s_lshl_b32 s33, s3, 1
    s_add_u32 s7, s7, s33
    s_lshl_b32 s33, s7, 10
    v_add_u32 v1, s33, v1
    s_waitcnt lgkmcnt(0)
    global_load_dwordx4 v[8:11], v1, s[36:37]
    global_load_dwordx4 v[12:15], v1, s[36:37] offset:512
    s_setprio 0
    s_mov_b32 s88, s7
    s_mov_b32 s20, s66
    s_mov_b32 s21, s67
    s_mov_b32 s22, 5636096
    s_mov_b32 s23, 0x20000
    s_and_b32 s68, s3, 1
    s_lshr_b32 s69, s3, 1
    s_mov_b32 s30, 4294885376
    s_mov_b32 s31, 40960
    v_and_b32 v1, 31, v0
    v_lshrrev_b32 v2, 5, v0
    v_lshrrev_b32 v3, 1, v1
    v_and_b32 v3, 7, v3
    s_lshl_b32 s7, s68, 6
    v_add_u32 v4, s7, v1
    v_lshlrev_b32 v4, 7, v4
    v_add_u32 v5, 0, v2
    v_xor_b32 v5, v5, v3
    v_lshlrev_b32 v5, 4, v5
    v_add_u32 v48, v4, v5
    v_add_u32 v5, 2, v2
    v_xor_b32 v5, v5, v3
    v_lshlrev_b32 v5, 4, v5
    v_add_u32 v49, v4, v5
    v_add_u32 v5, 4, v2
    v_xor_b32 v5, v5, v3
    v_lshlrev_b32 v5, 4, v5
    v_add_u32 v50, v4, v5
    v_add_u32 v5, 6, v2
    v_xor_b32 v5, v5, v3
    v_lshlrev_b32 v5, 4, v5
    v_add_u32 v51, v4, v5
    v_lshrrev_b32 v3, 4, v0
    v_and_b32 v3, 1, v3
    v_mul_u32_u24 v4, 12288, v3
    v_lshlrev_b32 v5, 9, v2
    v_add_u32 v4, v4, v5
    v_and_b32 v5, 15, v0
    v_lshrrev_b32 v6, 2, v5
    v_lshlrev_b32 v6, 6, v6
    v_add_u32 v4, v4, v6
    v_and_b32 v5, 3, v5
    v_lshlrev_b32 v5, 3, v5
    v_add_u32 v4, v4, v5
    v_add_u32 v4, 16384, v4
    s_mul_i32 s7, s69, 3
    s_add_u32 s32, s7, 0
    s_lshr_b32 s33, s32, 1
    s_lshl_b32 s33, s33, 12
    s_and_b32 s32, s32, 1
    v_xor_b32 v5, s32, v3
    v_lshlrev_b32 v5, 5, v5
    v_add_u32 v5, s33, v5
    v_add_u32 v52, v4, v5
    s_add_u32 s32, s7, 1
    s_lshr_b32 s33, s32, 1
    s_lshl_b32 s33, s33, 12
    s_and_b32 s32, s32, 1
    v_xor_b32 v5, s32, v3
    v_lshlrev_b32 v5, 5, v5
    v_add_u32 v5, s33, v5
    v_add_u32 v53, v4, v5
    s_add_u32 s32, s7, 2
    s_lshr_b32 s33, s32, 1
    s_lshl_b32 s33, s33, 12
    s_and_b32 s32, s32, 1
    v_xor_b32 v5, s32, v3
    v_lshlrev_b32 v5, 5, v5
    v_add_u32 v5, s33, v5
    v_add_u32 v54, v4, v5
    v_mov_b32 v64, 0
    v_mov_b32 v65, 0
    v_mov_b32 v66, 0
    v_mov_b32 v67, 0
    v_mov_b32 v68, 0
    v_mov_b32 v69, 0
    v_mov_b32 v70, 0
    v_mov_b32 v71, 0
    v_mov_b32 v72, 0
    v_mov_b32 v73, 0
    v_mov_b32 v74, 0
    v_mov_b32 v75, 0
    v_mov_b32 v76, 0
    v_mov_b32 v77, 0
    v_mov_b32 v78, 0
    v_mov_b32 v79, 0
    v_mov_b32 v80, 0
    v_mov_b32 v81, 0
    v_mov_b32 v82, 0
    v_mov_b32 v83, 0
    v_mov_b32 v84, 0
    v_mov_b32 v85, 0
    v_mov_b32 v86, 0
    v_mov_b32 v87, 0
    v_mov_b32 v88, 0
    v_mov_b32 v89, 0
    v_mov_b32 v90, 0
    v_mov_b32 v91, 0
    v_mov_b32 v92, 0
    v_mov_b32 v93, 0
    v_mov_b32 v94, 0
    v_mov_b32 v95, 0
    v_mov_b32 v96, 0
    v_mov_b32 v97, 0
    v_mov_b32 v98, 0
    v_mov_b32 v99, 0
    v_mov_b32 v100, 0
    v_mov_b32 v101, 0
    v_mov_b32 v102, 0
    v_mov_b32 v103, 0
    v_mov_b32 v104, 0
    v_mov_b32 v105, 0
    v_mov_b32 v106, 0
    v_mov_b32 v107, 0
    v_mov_b32 v108, 0
    v_mov_b32 v109, 0
    v_mov_b32 v110, 0
    v_mov_b32 v111, 0
    v_mov_b32 v112, 0
    v_mov_b32 v113, 0
    v_mov_b32 v114, 0
    v_mov_b32 v115, 0
    v_mov_b32 v116, 0
    v_mov_b32 v117, 0
    v_mov_b32 v118, 0
    v_mov_b32 v119, 0
    v_mov_b32 v120, 0
    v_mov_b32 v121, 0
    v_mov_b32 v122, 0
    v_mov_b32 v123, 0
    v_mov_b32 v124, 0
    v_mov_b32 v125, 0
    v_mov_b32 v126, 0
    v_mov_b32 v127, 0
    v_mov_b32 v128, 0
    v_mov_b32 v129, 0
    v_mov_b32 v130, 0
    v_mov_b32 v131, 0
    v_mov_b32 v132, 0
    v_mov_b32 v133, 0
    v_mov_b32 v134, 0
    v_mov_b32 v135, 0
    v_mov_b32 v136, 0
    v_mov_b32 v137, 0
    v_mov_b32 v138, 0
    v_mov_b32 v139, 0
    v_mov_b32 v140, 0
    v_mov_b32 v141, 0
    v_mov_b32 v142, 0
    v_mov_b32 v143, 0
    v_mov_b32 v144, 0
    v_mov_b32 v145, 0
    v_mov_b32 v146, 0
    v_mov_b32 v147, 0
    v_mov_b32 v148, 0
    v_mov_b32 v149, 0
    v_mov_b32 v150, 0
    v_mov_b32 v151, 0
    v_mov_b32 v152, 0
    v_mov_b32 v153, 0
    v_mov_b32 v154, 0
    v_mov_b32 v155, 0
    v_mov_b32 v156, 0
    v_mov_b32 v157, 0
    v_mov_b32 v158, 0
    v_mov_b32 v159, 0
    v_lshlrev_b32 v5, 2, v0
    v_add_u32 v5, 158528, v5
    v_mov_b32 v6, 0
    s_mov_b64 exec, 0xffffffff
    ds_write_b32 v5, v6
    s_mov_b64 exec, -1
    s_mov_b32 s7, s88
    s_waitcnt vmcnt(0)
    v_lshlrev_b32 v16, 16, v8
    v_and_b32 v17, 0xffff0000, v8
    v_lshlrev_b32 v18, 16, v9
    v_and_b32 v19, 0xffff0000, v9
    v_lshlrev_b32 v20, 16, v10
    v_and_b32 v21, 0xffff0000, v10
    v_lshlrev_b32 v22, 16, v11
    v_and_b32 v23, 0xffff0000, v11
    v_lshlrev_b32 v24, 16, v12
    v_and_b32 v25, 0xffff0000, v12
    v_lshlrev_b32 v26, 16, v13
    v_and_b32 v27, 0xffff0000, v13
    v_lshlrev_b32 v28, 16, v14
    v_and_b32 v29, 0xffff0000, v14
    v_lshlrev_b32 v30, 16, v15
    v_and_b32 v31, 0xffff0000, v15
    v_add_f32 v2, v16, v17
    v_add_f32 v3, v18, v19
    v_add_f32 v2, v2, v20
    v_add_f32 v2, v2, v21
    v_add_f32 v3, v3, v22
    v_add_f32 v3, v3, v23
    v_add_f32 v2, v2, v24
    v_add_f32 v2, v2, v25
    v_add_f32 v3, v3, v26
    v_add_f32 v3, v3, v27
    v_add_f32 v2, v2, v28
    v_add_f32 v2, v2, v29
    v_add_f32 v3, v3, v30
    v_add_f32 v3, v3, v31
    v_add_f32 v2, v2, v3
    s_nop 1
    v_add_f32_dpp v2, v2, v2 quad_perm:[1,0,3,2] row_mask:0xf bank_mask:0xf
    s_nop 1
    v_add_f32_dpp v2, v2, v2 quad_perm:[2,3,0,1] row_mask:0xf bank_mask:0xf
    s_nop 1
    v_add_f32_dpp v2, v2, v2 row_half_mirror row_mask:0xf bank_mask:0xf
    s_nop 1
    v_add_f32_dpp v2, v2, v2 row_mirror row_mask:0xf bank_mask:0xf
    v_mov_b32 v5, v2
    s_nop 1
    v_permlane16_swap_b32 v2, v5
    s_nop 1
    v_add_f32 v2, v2, v5
    v_mul_f32 v2, 0x3b000000, v2
    v_mov_b32 v3, 0
    v_mov_b32 v4, 0
    v_sub_f32 v16, v16, v2
    v_sub_f32 v17, v17, v2
    v_sub_f32 v18, v18, v2
    v_sub_f32 v19, v19, v2
    v_sub_f32 v20, v20, v2
    v_sub_f32 v21, v21, v2
    v_sub_f32 v22, v22, v2
    v_sub_f32 v23, v23, v2
    v_sub_f32 v24, v24, v2
    v_sub_f32 v25, v25, v2
    v_sub_f32 v26, v26, v2
    v_sub_f32 v27, v27, v2
    v_sub_f32 v28, v28, v2
    v_sub_f32 v29, v29, v2
    v_sub_f32 v30, v30, v2
    v_sub_f32 v31, v31, v2
    v_fmac_f32 v3, v16, v16
    v_fmac_f32 v4, v17, v17
    v_fmac_f32 v3, v18, v18
    v_fmac_f32 v4, v19, v19
    v_fmac_f32 v3, v20, v20
    v_fmac_f32 v4, v21, v21
    v_fmac_f32 v3, v22, v22
    v_fmac_f32 v4, v23, v23
    v_fmac_f32 v3, v24, v24
    v_fmac_f32 v4, v25, v25
    v_fmac_f32 v3, v26, v26
    v_fmac_f32 v4, v27, v27
    v_fmac_f32 v3, v28, v28
    v_fmac_f32 v4, v29, v29
    v_fmac_f32 v3, v30, v30
    v_fmac_f32 v4, v31, v31
    v_add_f32 v4, v4, v3
    s_nop 1
    v_add_f32_dpp v4, v4, v4 quad_perm:[1,0,3,2] row_mask:0xf bank_mask:0xf
    s_nop 1
    v_add_f32_dpp v4, v4, v4 quad_perm:[2,3,0,1] row_mask:0xf bank_mask:0xf
    s_nop 1
    v_add_f32_dpp v4, v4, v4 row_half_mirror row_mask:0xf bank_mask:0xf
    s_nop 1
    v_add_f32_dpp v4, v4, v4 row_mirror row_mask:0xf bank_mask:0xf
    v_mov_b32 v5, v4
    s_nop 1
    v_permlane16_swap_b32 v4, v5
    s_nop 1
    v_add_f32 v4, v4, v5
    v_mul_f32 v4, 0x3b000000, v4
    v_cvt_pk_bf16_f32 v2, v2, v4
    v_and_b32 v4, 0xffff0000, v2
    v_add_f32 v4, 0x3727c5ac, v4
    v_cvt_pk_bf16_f32 v4, v4, v4
    v_and_b32 v4, 0xffff0000, v4
    v_sqrt_f32 v4, v4
    v_and_b32 v2, 0xffff, v2
    v_cvt_pk_bf16_f32 v4, v4, v4
    v_and_b32 v4, 0xffff0000, v4
    v_or_b32 v2, v2, v4
    v_lshrrev_b32 v1, 5, v0
    s_lshl_b32 s33, s3, 1
    v_add_u32 v1, s33, v1
    v_lshlrev_b32 v1, 2, v1
    v_add_u32 v1, 158464, v1
    ds_write_b32 v1, v2
    s_waitcnt lgkmcnt(0)
    s_lshl_b32 s7, s5, 1
    s_add_u32 s7, s7, s69
    s_cmp_lt_u32 s7, 29
    s_cbranch_scc1 L_busy_40
    s_mov_b32 s7, 8
L_idle_41:
    s_barrier
    s_sub_u32 s7, s7, 1
    s_cmp_lg_u32 s7, 0
    s_cbranch_scc1 L_idle_41
    v_mov_b32 v1, 158588
    v_mov_b32 v2, 1
    s_mov_b64 exec, 1
    ds_add_u32 v1, v2
    s_mov_b64 exec, -1
    s_branch L_gpub_42
L_busy_40:
    s_barrier
    ds_read_b128 v[32:35], v48
    ds_read_b64_tr_b16 v[8:9], v52 offset:0
    ds_read_b64_tr_b16 v[10:11], v52 offset:256
    ds_read_b128 v[36:39], v48 offset:4096
    ds_read_b64_tr_b16 v[12:13], v53 offset:0
    ds_read_b64_tr_b16 v[14:15], v53 offset:256
    ds_read_b64_tr_b16 v[16:17], v54 offset:0
    ds_read_b64_tr_b16 v[18:19], v54 offset:256
    s_mov_b32 s27, 0
    s_mov_b32 s26, 0
L_gloop_43:
    s_waitcnt lgkmcnt(0)
    v_mfma_f32_32x32x16_bf16 v[64:79], v[8:11], v[32:35], v[64:79]
    ds_read_b128 v[40:43], v49
    ds_read_b64_tr_b16 v[20:21], v52 offset:1024
    v_mfma_f32_32x32x16_bf16 v[80:95], v[8:11], v[36:39], v[80:95]
    ds_read_b64_tr_b16 v[22:23], v52 offset:1280
    ds_read_b128 v[44:47], v49 offset:4096
    v_mfma_f32_32x32x16_bf16 v[96:111], v[12:15], v[32:35], v[96:111]
    ds_read_b64_tr_b16 v[24:25], v53 offset:1024
    ds_read_b64_tr_b16 v[26:27], v53 offset:1280
    v_mfma_f32_32x32x16_bf16 v[112:127], v[12:15], v[36:39], v[112:127]
    ds_read_b64_tr_b16 v[28:29], v54 offset:1024
    ds_read_b64_tr_b16 v[30:31], v54 offset:1280
    v_mfma_f32_32x32x16_bf16 v[128:143], v[16:19], v[32:35], v[128:143]
    v_mfma_f32_32x32x16_bf16 v[144:159], v[16:19], v[36:39], v[144:159]
    s_waitcnt lgkmcnt(0)
    v_mfma_f32_32x32x16_bf16 v[64:79], v[20:23], v[40:43], v[64:79]
    ds_read_b128 v[32:35], v50
    ds_read_b64_tr_b16 v[8:9], v52 offset:2048
    v_mfma_f32_32x32x16_bf16 v[80:95], v[20:23], v[44:47], v[80:95]
    ds_read_b64_tr_b16 v[10:11], v52 offset:2304
    ds_read_b128 v[36:39], v50 offset:4096
    v_mfma_f32_32x32x16_bf16 v[96:111], v[24:27], v[40:43], v[96:111]
    ds_read_b64_tr_b16 v[12:13], v53 offset:2048
    ds_read_b64_tr_b16 v[14:15], v53 offset:2304
    v_mfma_f32_32x32x16_bf16 v[112:127], v[24:27], v[44:47], v[112:127]
    ds_read_b64_tr_b16 v[16:17], v54 offset:2048
    ds_read_b64_tr_b16 v[18:19], v54 offset:2304
    v_mfma_f32_32x32x16_bf16 v[128:143], v[28:31], v[40:43], v[128:143]
    v_mfma_f32_32x32x16_bf16 v[144:159], v[28:31], v[44:47], v[144:159]
    s_waitcnt lgkmcnt(0)
    v_mfma_f32_32x32x16_bf16 v[64:79], v[8:11], v[32:35], v[64:79]
    ds_read_b128 v[40:43], v51
    ds_read_b64_tr_b16 v[20:21], v52 offset:3072
    v_mfma_f32_32x32x16_bf16 v[80:95], v[8:11], v[36:39], v[80:95]
    ds_read_b64_tr_b16 v[22:23], v52 offset:3328
    ds_read_b128 v[44:47], v51 offset:4096
    v_mfma_f32_32x32x16_bf16 v[96:111], v[12:15], v[32:35], v[96:111]
    ds_read_b64_tr_b16 v[24:25], v53 offset:3072
    ds_read_b64_tr_b16 v[26:27], v53 offset:3328
    v_mfma_f32_32x32x16_bf16 v[112:127], v[12:15], v[36:39], v[112:127]
    ds_read_b64_tr_b16 v[28:29], v54 offset:3072
    ds_read_b64_tr_b16 v[30:31], v54 offset:3328
    v_mfma_f32_32x32x16_bf16 v[128:143], v[16:19], v[32:35], v[128:143]
    v_mfma_f32_32x32x16_bf16 v[144:159], v[16:19], v[36:39], v[144:159]
    s_waitcnt lgkmcnt(0)
    s_cmp_eq_u32 s27, 7
    s_cbranch_scc1 L_gend_44
    s_barrier
    s_add_u32 s26, s26, 40960
    s_cmp_eq_u32 s26, 122880
    s_cselect_b32 s25, s30, s31
    s_cselect_b32 s26, 0, s26
    s_add_u32 s27, s27, 1
    v_add_u32 v48, s25, v48
    v_add_u32 v52, s25, v52
    v_add_u32 v53, s25, v53
    v_add_u32 v54, s25, v54
    v_mfma_f32_32x32x16_bf16 v[64:79], v[20:23], v[40:43], v[64:79]
    ds_read_b128 v[32:35], v48
    ds_read_b64_tr_b16 v[8:9], v52 offset:0
    v_mfma_f32_32x32x16_bf16 v[80:95], v[20:23], v[44:47], v[80:95]
    ds_read_b64_tr_b16 v[10:11], v52 offset:256
    ds_read_b128 v[36:39], v48 offset:4096
    v_mfma_f32_32x32x16_bf16 v[96:111], v[24:27], v[40:43], v[96:111]
    ds_read_b64_tr_b16 v[12:13], v53 offset:0
    ds_read_b64_tr_b16 v[14:15], v53 offset:256
    v_mfma_f32_32x32x16_bf16 v[112:127], v[24:27], v[44:47], v[112:127]
    ds_read_b64_tr_b16 v[16:17], v54 offset:0
    ds_read_b64_tr_b16 v[18:19], v54 offset:256
    v_mfma_f32_32x32x16_bf16 v[128:143], v[28:31], v[40:43], v[128:143]
    v_mfma_f32_32x32x16_bf16 v[144:159], v[28:31], v[44:47], v[144:159]
    v_add_u32 v49, s25, v49
    v_add_u32 v50, s25, v50
    v_add_u32 v51, s25, v51
    s_branch L_gloop_43
L_gend_44:
    v_and_b32 v1, 31, v0
    s_lshl_b32 s7, s68, 6
    v_add_u32 v1, s7, v1
    v_lshlrev_b32 v2, 3, v1
    v_add_u32 v2, 155648, v2
    ds_read_b64 v[8:9], v2
    ds_read_b64 v[10:11], v2 offset:256
    v_mfma_f32_32x32x16_bf16 v[64:79], v[20:23], v[40:43], v[64:79]
    v_mfma_f32_32x32x16_bf16 v[80:95], v[20:23], v[44:47], v[80:95]
    v_mfma_f32_32x32x16_bf16 v[96:111], v[24:27], v[40:43], v[96:111]
    v_mfma_f32_32x32x16_bf16 v[112:127], v[24:27], v[44:47], v[112:127]
    v_mfma_f32_32x32x16_bf16 v[128:143], v[28:31], v[40:43], v[128:143]
    v_mfma_f32_32x32x16_bf16 v[144:159], v[28:31], v[44:47], v[144:159]
    s_waitcnt lgkmcnt(0)
    v_mov_b32 v12, v8
    v_rcp_f32 v1, v9
    v_mul_f32 v18, v9, v9
    v_mul_f32 v14, 0xc0135761, v1
    v_mul_f32 v2, v1, v1
    v_mul_f32 v2, 0x3d372713, v2
    v_mul_f32 v16, v14, v2
    v_mov_b32 v20, v10
    v_rcp_f32 v1, v11
    v_mul_f32 v26, v11, v11
    v_mul_f32 v22, 0xc0135761, v1
    v_mul_f32 v2, v1, v1
    v_mul_f32 v2, 0x3d372713, v2
    v_mul_f32 v24, v22, v2
    v_mov_b32 v1, 158588
    v_mov_b32 v2, 1
    s_mov_b64 exec, 1
    ds_add_u32 v1, v2
    s_mov_b64 exec, -1
    v_mov_b32 v1, 158584
    s_mov_b32 s99, 0
L_spin_45:
    ds_read_b32 v3, v1
    s_add_u32 s99, s99, 1
    s_waitcnt lgkmcnt(0)
    v_readfirstlane_b32 s24, v3
    s_cmp_gt_u32 s99, 1000000
    s_cselect_b32 s24, 1, s24
    s_cmp_eq_u32 s24, 0
    s_cbranch_scc1 L_spin_45
    s_setprio 2
    v_lshrrev_b32 v3, 5, v0
    v_lshlrev_b32 v3, 4, v3
    s_mul_i32 s7, s69, 384
    s_add_u32 s7, s7, 156672
    v_add_u32 v3, s7, v3
    v_lshlrev_b32 v4, 4, v0
    ds_read_b128 v[32:35], v3 offset:0
    ds_read_b128 v[36:39], v3 offset:32
    ds_read_b128 v[40:43], v3 offset:64
    ds_read_b128 v[44:47], v3 offset:96
    s_lshl_b32 s32, s4, 2
    s_lshl_b32 s7, s68, 1
    s_add_u32 s32, s32, s7
    s_mul_i32 s32, s32, 86
    s_mul_i32 s28, s5, 6
    s_mul_i32 s7, s69, 3
    s_add_u32 s28, s28, s7
    s_waitcnt lgkmcnt(0)
    v_pk_fma_f32 v[64:65], v[32:33], v[12:13], v[64:65] op_sel_hi:[1,0,1] neg_lo:[0,1,0] neg_hi:[0,1,0]
    v_pk_fma_f32 v[66:67], v[34:35], v[12:13], v[66:67] op_sel_hi:[1,0,1] neg_lo:[0,1,0] neg_hi:[0,1,0]
    v_pk_fma_f32 v[68:69], v[36:37], v[12:13], v[68:69] op_sel_hi:[1,0,1] neg_lo:[0,1,0] neg_hi:[0,1,0]
    v_pk_fma_f32 v[70:71], v[38:39], v[12:13], v[70:71] op_sel_hi:[1,0,1] neg_lo:[0,1,0] neg_hi:[0,1,0]
    v_pk_fma_f32 v[72:73], v[40:41], v[12:13], v[72:73] op_sel_hi:[1,0,1] neg_lo:[0,1,0] neg_hi:[0,1,0]
    v_pk_fma_f32 v[74:75], v[42:43], v[12:13], v[74:75] op_sel_hi:[1,0,1] neg_lo:[0,1,0] neg_hi:[0,1,0]
    v_pk_fma_f32 v[76:77], v[44:45], v[12:13], v[76:77] op_sel_hi:[1,0,1] neg_lo:[0,1,0] neg_hi:[0,1,0]
    v_pk_fma_f32 v[78:79], v[46:47], v[12:13], v[78:79] op_sel_hi:[1,0,1] neg_lo:[0,1,0] neg_hi:[0,1,0]
    v_pk_fma_f32 v[80:81], v[32:33], v[20:21], v[80:81] op_sel_hi:[1,0,1] neg_lo:[0,1,0] neg_hi:[0,1,0]
    v_pk_fma_f32 v[82:83], v[34:35], v[20:21], v[82:83] op_sel_hi:[1,0,1] neg_lo:[0,1,0] neg_hi:[0,1,0]
    v_pk_fma_f32 v[84:85], v[36:37], v[20:21], v[84:85] op_sel_hi:[1,0,1] neg_lo:[0,1,0] neg_hi:[0,1,0]
    v_pk_fma_f32 v[86:87], v[38:39], v[20:21], v[86:87] op_sel_hi:[1,0,1] neg_lo:[0,1,0] neg_hi:[0,1,0]
    v_pk_fma_f32 v[88:89], v[40:41], v[20:21], v[88:89] op_sel_hi:[1,0,1] neg_lo:[0,1,0] neg_hi:[0,1,0]
    v_pk_fma_f32 v[90:91], v[42:43], v[20:21], v[90:91] op_sel_hi:[1,0,1] neg_lo:[0,1,0] neg_hi:[0,1,0]
    v_pk_fma_f32 v[92:93], v[44:45], v[20:21], v[92:93] op_sel_hi:[1,0,1] neg_lo:[0,1,0] neg_hi:[0,1,0]
    v_pk_fma_f32 v[94:95], v[46:47], v[20:21], v[94:95] op_sel_hi:[1,0,1] neg_lo:[0,1,0] neg_hi:[0,1,0]
    ds_read_b128 v[32:35], v3 offset:128
    ds_read_b128 v[36:39], v3 offset:160
    ds_read_b128 v[40:43], v3 offset:192
    ds_read_b128 v[44:47], v3 offset:224
    v_pk_mul_f32 v[48:49], v[64:65], v[64:65]
    v_pk_mul_f32 v[56:57], v[80:81], v[80:81]
    v_pk_fma_f32 v[48:49], v[48:49], v[16:17], v[14:15] op_sel_hi:[1,0,0]
    v_pk_fma_f32 v[56:57], v[56:57], v[24:25], v[22:23] op_sel_hi:[1,0,0]
    v_pk_mul_f32 v[48:49], v[48:49], v[64:65]
    v_pk_mul_f32 v[56:57], v[56:57], v[80:81]
    v_pk_mul_f32 v[50:51], v[64:65], v[72:73]
    v_pk_mul_f32 v[58:59], v[80:81], v[88:89]
    v_exp_f32 v48, v48
    v_exp_f32 v49, v49
    v_exp_f32 v56, v56
    v_exp_f32 v57, v57
    v_pk_fma_f32 v[48:49], v[48:49], v[18:19], v[18:19] op_sel_hi:[1,0,0]
    v_pk_fma_f32 v[56:57], v[56:57], v[26:27], v[26:27] op_sel_hi:[1,0,0]
    v_rcp_f32 v48, v48
    v_rcp_f32 v49, v49
    v_rcp_f32 v56, v56
    v_rcp_f32 v57, v57
    v_pk_mul_f32 v[50:51], v[50:51], v[48:49]
    v_pk_mul_f32 v[58:59], v[58:59], v[56:57]
    v_cvt_pk_bf16_f32 v28, v50, v51
    v_cvt_pk_bf16_f32 v160, v58, v59
    v_pk_mul_f32 v[48:49], v[66:67], v[66:67]
    v_pk_mul_f32 v[56:57], v[82:83], v[82:83]
    v_pk_fma_f32 v[48:49], v[48:49], v[16:17], v[14:15] op_sel_hi:[1,0,0]
    v_pk_fma_f32 v[56:57], v[56:57], v[24:25], v[22:23] op_sel_hi:[1,0,0]
    v_pk_mul_f32 v[48:49], v[48:49], v[66:67]
    v_pk_mul_f32 v[56:57], v[56:57], v[82:83]
    v_pk_mul_f32 v[50:51], v[66:67], v[74:75]
    v_pk_mul_f32 v[58:59], v[82:83], v[90:91]
    v_exp_f32 v48, v48
    v_exp_f32 v49, v49
    v_exp_f32 v56, v56
    v_exp_f32 v57, v57
    v_pk_fma_f32 v[48:49], v[48:49], v[18:19], v[18:19] op_sel_hi:[1,0,0]
    v_pk_fma_f32 v[56:57], v[56:57], v[26:27], v[26:27] op_sel_hi:[1,0,0]
    v_rcp_f32 v48, v48
    v_rcp_f32 v49, v49
    v_rcp_f32 v56, v56
    v_rcp_f32 v57, v57
    v_pk_mul_f32 v[50:51], v[50:51], v[48:49]
    v_pk_mul_f32 v[58:59], v[58:59], v[56:57]
    v_cvt_pk_bf16_f32 v29, v50, v51
    v_cvt_pk_bf16_f32 v161, v58, v59
    v_pk_mul_f32 v[48:49], v[68:69], v[68:69]
    v_pk_mul_f32 v[56:57], v[84:85], v[84:85]
    v_pk_fma_f32 v[48:49], v[48:49], v[16:17], v[14:15] op_sel_hi:[1,0,0]
    v_pk_fma_f32 v[56:57], v[56:57], v[24:25], v[22:23] op_sel_hi:[1,0,0]
    v_pk_mul_f32 v[48:49], v[48:49], v[68:69]
    v_pk_mul_f32 v[56:57], v[56:57], v[84:85]
    v_pk_mul_f32 v[50:51], v[68:69], v[76:77]
    v_pk_mul_f32 v[58:59], v[84:85], v[92:93]
    v_exp_f32 v48, v48
    v_exp_f32 v49, v49
    v_exp_f32 v56, v56
    v_exp_f32 v57, v57
    v_pk_fma_f32 v[48:49], v[48:49], v[18:19], v[18:19] op_sel_hi:[1,0,0]
    v_pk_fma_f32 v[56:57], v[56:57], v[26:27], v[26:27] op_sel_hi:[1,0,0]
    v_rcp_f32 v48, v48
    v_rcp_f32 v49, v49
    v_rcp_f32 v56, v56
    v_rcp_f32 v57, v57
    v_pk_mul_f32 v[50:51], v[50:51], v[48:49]
    v_pk_mul_f32 v[58:59], v[58:59], v[56:57]
    v_cvt_pk_bf16_f32 v30, v50, v51
    v_cvt_pk_bf16_f32 v162, v58, v59
    v_pk_mul_f32 v[48:49], v[70:71], v[70:71]
    v_pk_mul_f32 v[56:57], v[86:87], v[86:87]
    v_pk_fma_f32 v[48:49], v[48:49], v[16:17], v[14:15] op_sel_hi:[1,0,0]
    v_pk_fma_f32 v[56:57], v[56:57], v[24:25], v[22:23] op_sel_hi:[1,0,0]
    v_pk_mul_f32 v[48:49], v[48:49], v[70:71]
    v_pk_mul_f32 v[56:57], v[56:57], v[86:87]
    v_pk_mul_f32 v[50:51], v[70:71], v[78:79]
    v_pk_mul_f32 v[58:59], v[86:87], v[94:95]
    v_exp_f32 v48, v48
    v_exp_f32 v49, v49
    v_exp_f32 v56, v56
    v_exp_f32 v57, v57
    v_pk_fma_f32 v[48:49], v[48:49], v[18:19], v[18:19] op_sel_hi:[1,0,0]
    v_pk_fma_f32 v[56:57], v[56:57], v[26:27], v[26:27] op_sel_hi:[1,0,0]
    v_rcp_f32 v48, v48
    v_rcp_f32 v49, v49
    v_rcp_f32 v56, v56
    v_rcp_f32 v57, v57
    v_pk_mul_f32 v[50:51], v[50:51], v[48:49]
    v_pk_mul_f32 v[58:59], v[58:59], v[56:57]
    v_cvt_pk_bf16_f32 v31, v50, v51
    v_cvt_pk_bf16_f32 v163, v58, v59
    s_add_u32 s7, s28, 0
    s_cmp_ge_u32 s7, 86
    s_cbranch_scc1 L_skip_46
    s_add_u32 s7, s7, s32
    s_lshl_b32 s7, s7, 10
    buffer_store_dwordx4 v[28:31], v4, s[20:23], s7 offen sc1
    s_add_u32 s7, s7, 88064
    buffer_store_dwordx4 v[160:163], v4, s[20:23], s7 offen sc1
L_skip_46:
    s_nop 1
    s_waitcnt lgkmcnt(0)
    v_pk_fma_f32 v[96:97], v[32:33], v[12:13], v[96:97] op_sel_hi:[1,0,1] neg_lo:[0,1,0] neg_hi:[0,1,0]
    v_pk_fma_f32 v[98:99], v[34:35], v[12:13], v[98:99] op_sel_hi:[1,0,1] neg_lo:[0,1,0] neg_hi:[0,1,0]
    v_pk_fma_f32 v[100:101], v[36:37], v[12:13], v[100:101] op_sel_hi:[1,0,1] neg_lo:[0,1,0] neg_hi:[0,1,0]
    v_pk_fma_f32 v[102:103], v[38:39], v[12:13], v[102:103] op_sel_hi:[1,0,1] neg_lo:[0,1,0] neg_hi:[0,1,0]
    v_pk_fma_f32 v[104:105], v[40:41], v[12:13], v[104:105] op_sel_hi:[1,0,1] neg_lo:[0,1,0] neg_hi:[0,1,0]
    v_pk_fma_f32 v[106:107], v[42:43], v[12:13], v[106:107] op_sel_hi:[1,0,1] neg_lo:[0,1,0] neg_hi:[0,1,0]
    v_pk_fma_f32 v[108:109], v[44:45], v[12:13], v[108:109] op_sel_hi:[1,0,1] neg_lo:[0,1,0] neg_hi:[0,1,0]
    v_pk_fma_f32 v[110:111], v[46:47], v[12:13], v[110:111] op_sel_hi:[1,0,1] neg_lo:[0,1,0] neg_hi:[0,1,0]
    v_pk_fma_f32 v[112:113], v[32:33], v[20:21], v[112:113] op_sel_hi:[1,0,1] neg_lo:[0,1,0] neg_hi:[0,1,0]
    v_pk_fma_f32 v[114:115], v[34:35], v[20:21], v[114:115] op_sel_hi:[1,0,1] neg_lo:[0,1,0] neg_hi:[0,1,0]
    v_pk_fma_f32 v[116:117], v[36:37], v[20:21], v[116:117] op_sel_hi:[1,0,1] neg_lo:[0,1,0] neg_hi:[0,1,0]
    v_pk_fma_f32 v[118:119], v[38:39], v[20:21], v[118:119] op_sel_hi:[1,0,1] neg_lo:[0,1,0] neg_hi:[0,1,0]
    v_pk_fma_f32 v[120:121], v[40:41], v[20:21], v[120:121] op_sel_hi:[1,0,1] neg_lo:[0,1,0] neg_hi:[0,1,0]
    v_pk_fma_f32 v[122:123], v[42:43], v[20:21], v[122:123] op_sel_hi:[1,0,1] neg_lo:[0,1,0] neg_hi:[0,1,0]
    v_pk_fma_f32 v[124:125], v[44:45], v[20:21], v[124:125] op_sel_hi:[1,0,1] neg_lo:[0,1,0] neg_hi:[0,1,0]
    v_pk_fma_f32 v[126:127], v[46:47], v[20:21], v[126:127] op_sel_hi:[1,0,1] neg_lo:[0,1,0] neg_hi:[0,1,0]
    ds_read_b128 v[32:35], v3 offset:256
    ds_read_b128 v[36:39], v3 offset:288
    ds_read_b128 v[40:43], v3 offset:320
    ds_read_b128 v[44:47], v3 offset:352
    v_pk_mul_f32 v[48:49], v[96:97], v[96:97]
    v_pk_mul_f32 v[56:57], v[112:113], v[112:113]
    v_pk_fma_f32 v[48:49], v[48:49], v[16:17], v[14:15] op_sel_hi:[1,0,0]
    v_pk_fma_f32 v[56:57], v[56:57], v[24:25], v[22:23] op_sel_hi:[1,0,0]
    v_pk_mul_f32 v[48:49], v[48:49], v[96:97]
    v_pk_mul_f32 v[56:57], v[56:57], v[112:113]
    v_pk_mul_f32 v[50:51], v[96:97], v[104:105]
    v_pk_mul_f32 v[58:59], v[112:113], v[120:121]
    v_exp_f32 v48, v48
    v_exp_f32 v49, v49
    v_exp_f32 v56, v56
    v_exp_f32 v57, v57
    v_pk_fma_f32 v[48:49], v[48:49], v[18:19], v[18:19] op_sel_hi:[1,0,0]
    v_pk_fma_f32 v[56:57], v[56:57], v[26:27], v[26:27] op_sel_hi:[1,0,0]
    v_rcp_f32 v48, v48
    v_rcp_f32 v49, v49
    v_rcp_f32 v56, v56
    v_rcp_f32 v57, v57
    v_pk_mul_f32 v[50:51], v[50:51], v[48:49]
    v_pk_mul_f32 v[58:59], v[58:59], v[56:57]
    v_cvt_pk_bf16_f32 v28, v50, v51
    v_cvt_pk_bf16_f32 v160, v58, v59
    v_pk_mul_f32 v[48:49], v[98:99], v[98:99]
    v_pk_mul_f32 v[56:57], v[114:115], v[114:115]
    v_pk_fma_f32 v[48:49], v[48:49], v[16:17], v[14:15] op_sel_hi:[1,0,0]
    v_pk_fma_f32 v[56:57], v[56:57], v[24:25], v[22:23] op_sel_hi:[1,0,0]
    v_pk_mul_f32 v[48:49], v[48:49], v[98:99]
    v_pk_mul_f32 v[56:57], v[56:57], v[114:115]
    v_pk_mul_f32 v[50:51], v[98:99], v[106:107]
    v_pk_mul_f32 v[58:59], v[114:115], v[122:123]
    v_exp_f32 v48, v48
    v_exp_f32 v49, v49
    v_exp_f32 v56, v56
    v_exp_f32 v57, v57
    v_pk_fma_f32 v[48:49], v[48:49], v[18:19], v[18:19] op_sel_hi:[1,0,0]
    v_pk_fma_f32 v[56:57], v[56:57], v[26:27], v[26:27] op_sel_hi:[1,0,0]
    v_rcp_f32 v48, v48
    v_rcp_f32 v49, v49
    v_rcp_f32 v56, v56
    v_rcp_f32 v57, v57
    v_pk_mul_f32 v[50:51], v[50:51], v[48:49]
    v_pk_mul_f32 v[58:59], v[58:59], v[56:57]
    v_cvt_pk_bf16_f32 v29, v50, v51
    v_cvt_pk_bf16_f32 v161, v58, v59
    v_pk_mul_f32 v[48:49], v[100:101], v[100:101]
    v_pk_mul_f32 v[56:57], v[116:117], v[116:117]
    v_pk_fma_f32 v[48:49], v[48:49], v[16:17], v[14:15] op_sel_hi:[1,0,0]
    v_pk_fma_f32 v[56:57], v[56:57], v[24:25], v[22:23] op_sel_hi:[1,0,0]
    v_pk_mul_f32 v[48:49], v[48:49], v[100:101]
    v_pk_mul_f32 v[56:57], v[56:57], v[116:117]
    v_pk_mul_f32 v[50:51], v[100:101], v[108:109]
    v_pk_mul_f32 v[58:59], v[116:117], v[124:125]
    v_exp_f32 v48, v48
    v_exp_f32 v49, v49
    v_exp_f32 v56, v56
    v_exp_f32 v57, v57
    v_pk_fma_f32 v[48:49], v[48:49], v[18:19], v[18:19] op_sel_hi:[1,0,0]
    v_pk_fma_f32 v[56:57], v[56:57], v[26:27], v[26:27] op_sel_hi:[1,0,0]
    v_rcp_f32 v48, v48
    v_rcp_f32 v49, v49
    v_rcp_f32 v56, v56
    v_rcp_f32 v57, v57
    v_pk_mul_f32 v[50:51], v[50:51], v[48:49]
    v_pk_mul_f32 v[58:59], v[58:59], v[56:57]
    v_cvt_pk_bf16_f32 v30, v50, v51
    v_cvt_pk_bf16_f32 v162, v58, v59
    v_pk_mul_f32 v[48:49], v[102:103], v[102:103]
    v_pk_mul_f32 v[56:57], v[118:119], v[118:119]
    v_pk_fma_f32 v[48:49], v[48:49], v[16:17], v[14:15] op_sel_hi:[1,0,0]
    v_pk_fma_f32 v[56:57], v[56:57], v[24:25], v[22:23] op_sel_hi:[1,0,0]
    v_pk_mul_f32 v[48:49], v[48:49], v[102:103]
    v_pk_mul_f32 v[56:57], v[56:57], v[118:119]
    v_pk_mul_f32 v[50:51], v[102:103], v[110:111]
    v_pk_mul_f32 v[58:59], v[118:119], v[126:127]
    v_exp_f32 v48, v48
    v_exp_f32 v49, v49
    v_exp_f32 v56, v56
    v_exp_f32 v57, v57
    v_pk_fma_f32 v[48:49], v[48:49], v[18:19], v[18:19] op_sel_hi:[1,0,0]
    v_pk_fma_f32 v[56:57], v[56:57], v[26:27], v[26:27] op_sel_hi:[1,0,0]
    v_rcp_f32 v48, v48
    v_rcp_f32 v49, v49
    v_rcp_f32 v56, v56
    v_rcp_f32 v57, v57
    v_pk_mul_f32 v[50:51], v[50:51], v[48:49]
    v_pk_mul_f32 v[58:59], v[58:59], v[56:57]
    v_cvt_pk_bf16_f32 v31, v50, v51
    v_cvt_pk_bf16_f32 v163, v58, v59
    s_add_u32 s7, s28, 1
    s_cmp_ge_u32 s7, 86
    s_cbranch_scc1 L_skip_47
    s_add_u32 s7, s7, s32
    s_lshl_b32 s7, s7, 10
    buffer_store_dwordx4 v[28:31], v4, s[20:23], s7 offen sc1
    s_add_u32 s7, s7, 88064
    buffer_store_dwordx4 v[160:163], v4, s[20:23], s7 offen sc1
L_skip_47:
    s_nop 1
    s_waitcnt lgkmcnt(0)
    v_pk_fma_f32 v[128:129], v[32:33], v[12:13], v[128:129] op_sel_hi:[1,0,1] neg_lo:[0,1,0] neg_hi:[0,1,0]
    v_pk_fma_f32 v[130:131], v[34:35], v[12:13], v[130:131] op_sel_hi:[1,0,1] neg_lo:[0,1,0] neg_hi:[0,1,0]
    v_pk_fma_f32 v[132:133], v[36:37], v[12:13], v[132:133] op_sel_hi:[1,0,1] neg_lo:[0,1,0] neg_hi:[0,1,0]
    v_pk_fma_f32 v[134:135], v[38:39], v[12:13], v[134:135] op_sel_hi:[1,0,1] neg_lo:[0,1,0] neg_hi:[0,1,0]
    v_pk_fma_f32 v[136:137], v[40:41], v[12:13], v[136:137] op_sel_hi:[1,0,1] neg_lo:[0,1,0] neg_hi:[0,1,0]
    v_pk_fma_f32 v[138:139], v[42:43], v[12:13], v[138:139] op_sel_hi:[1,0,1] neg_lo:[0,1,0] neg_hi:[0,1,0]
    v_pk_fma_f32 v[140:141], v[44:45], v[12:13], v[140:141] op_sel_hi:[1,0,1] neg_lo:[0,1,0] neg_hi:[0,1,0]
    v_pk_fma_f32 v[142:143], v[46:47], v[12:13], v[142:143] op_sel_hi:[1,0,1] neg_lo:[0,1,0] neg_hi:[0,1,0]
    v_pk_fma_f32 v[144:145], v[32:33], v[20:21], v[144:145] op_sel_hi:[1,0,1] neg_lo:[0,1,0] neg_hi:[0,1,0]
    v_pk_fma_f32 v[146:147], v[34:35], v[20:21], v[146:147] op_sel_hi:[1,0,1] neg_lo:[0,1,0] neg_hi:[0,1,0]
    v_pk_fma_f32 v[148:149], v[36:37], v[20:21], v[148:149] op_sel_hi:[1,0,1] neg_lo:[0,1,0] neg_hi:[0,1,0]
    v_pk_fma_f32 v[150:151], v[38:39], v[20:21], v[150:151] op_sel_hi:[1,0,1] neg_lo:[0,1,0] neg_hi:[0,1,0]
    v_pk_fma_f32 v[152:153], v[40:41], v[20:21], v[152:153] op_sel_hi:[1,0,1] neg_lo:[0,1,0] neg_hi:[0,1,0]
    v_pk_fma_f32 v[154:155], v[42:43], v[20:21], v[154:155] op_sel_hi:[1,0,1] neg_lo:[0,1,0] neg_hi:[0,1,0]
    v_pk_fma_f32 v[156:157], v[44:45], v[20:21], v[156:157] op_sel_hi:[1,0,1] neg_lo:[0,1,0] neg_hi:[0,1,0]
    v_pk_fma_f32 v[158:159], v[46:47], v[20:21], v[158:159] op_sel_hi:[1,0,1] neg_lo:[0,1,0] neg_hi:[0,1,0]
    v_pk_mul_f32 v[48:49], v[128:129], v[128:129]
    v_pk_mul_f32 v[56:57], v[144:145], v[144:145]
    v_pk_fma_f32 v[48:49], v[48:49], v[16:17], v[14:15] op_sel_hi:[1,0,0]
    v_pk_fma_f32 v[56:57], v[56:57], v[24:25], v[22:23] op_sel_hi:[1,0,0]
    v_pk_mul_f32 v[48:49], v[48:49], v[128:129]
    v_pk_mul_f32 v[56:57], v[56:57], v[144:145]
    v_pk_mul_f32 v[50:51], v[128:129], v[136:137]
    v_pk_mul_f32 v[58:59], v[144:145], v[152:153]
    v_exp_f32 v48, v48
    v_exp_f32 v49, v49
    v_exp_f32 v56, v56
    v_exp_f32 v57, v57
    v_pk_fma_f32 v[48:49], v[48:49], v[18:19], v[18:19] op_sel_hi:[1,0,0]
    v_pk_fma_f32 v[56:57], v[56:57], v[26:27], v[26:27] op_sel_hi:[1,0,0]
    v_rcp_f32 v48, v48
    v_rcp_f32 v49, v49
    v_rcp_f32 v56, v56
    v_rcp_f32 v57, v57
    v_pk_mul_f32 v[50:51], v[50:51], v[48:49]
    v_pk_mul_f32 v[58:59], v[58:59], v[56:57]
    v_cvt_pk_bf16_f32 v28, v50, v51
    v_cvt_pk_bf16_f32 v160, v58, v59
    v_pk_mul_f32 v[48:49], v[130:131], v[130:131]
    v_pk_mul_f32 v[56:57], v[146:147], v[146:147]
    v_pk_fma_f32 v[48:49], v[48:49], v[16:17], v[14:15] op_sel_hi:[1,0,0]
    v_pk_fma_f32 v[56:57], v[56:57], v[24:25], v[22:23] op_sel_hi:[1,0,0]
    v_pk_mul_f32 v[48:49], v[48:49], v[130:131]
    v_pk_mul_f32 v[56:57], v[56:57], v[146:147]
    v_pk_mul_f32 v[50:51], v[130:131], v[138:139]
    v_pk_mul_f32 v[58:59], v[146:147], v[154:155]
    v_exp_f32 v48, v48
    v_exp_f32 v49, v49
    v_exp_f32 v56, v56
    v_exp_f32 v57, v57
    v_pk_fma_f32 v[48:49], v[48:49], v[18:19], v[18:19] op_sel_hi:[1,0,0]
    v_pk_fma_f32 v[56:57], v[56:57], v[26:27], v[26:27] op_sel_hi:[1,0,0]
    v_rcp_f32 v48, v48
    v_rcp_f32 v49, v49
    v_rcp_f32 v56, v56
    v_rcp_f32 v57, v57
    v_pk_mul_f32 v[50:51], v[50:51], v[48:49]
    v_pk_mul_f32 v[58:59], v[58:59], v[56:57]
    v_cvt_pk_bf16_f32 v29, v50, v51
    v_cvt_pk_bf16_f32 v161, v58, v59
    v_pk_mul_f32 v[48:49], v[132:133], v[132:133]
    v_pk_mul_f32 v[56:57], v[148:149], v[148:149]
    v_pk_fma_f32 v[48:49], v[48:49], v[16:17], v[14:15] op_sel_hi:[1,0,0]
    v_pk_fma_f32 v[56:57], v[56:57], v[24:25], v[22:23] op_sel_hi:[1,0,0]
    v_pk_mul_f32 v[48:49], v[48:49], v[132:133]
    v_pk_mul_f32 v[56:57], v[56:57], v[148:149]
    v_pk_mul_f32 v[50:51], v[132:133], v[140:141]
    v_pk_mul_f32 v[58:59], v[148:149], v[156:157]
    v_exp_f32 v48, v48
    v_exp_f32 v49, v49
    v_exp_f32 v56, v56
    v_exp_f32 v57, v57
    v_pk_fma_f32 v[48:49], v[48:49], v[18:19], v[18:19] op_sel_hi:[1,0,0]
    v_pk_fma_f32 v[56:57], v[56:57], v[26:27], v[26:27] op_sel_hi:[1,0,0]
    v_rcp_f32 v48, v48
    v_rcp_f32 v49, v49
    v_rcp_f32 v56, v56
    v_rcp_f32 v57, v57
    v_pk_mul_f32 v[50:51], v[50:51], v[48:49]
    v_pk_mul_f32 v[58:59], v[58:59], v[56:57]
    v_cvt_pk_bf16_f32 v30, v50, v51
    v_cvt_pk_bf16_f32 v162, v58, v59
    v_pk_mul_f32 v[48:49], v[134:135], v[134:135]
    v_pk_mul_f32 v[56:57], v[150:151], v[150:151]
    v_pk_fma_f32 v[48:49], v[48:49], v[16:17], v[14:15] op_sel_hi:[1,0,0]
    v_pk_fma_f32 v[56:57], v[56:57], v[24:25], v[22:23] op_sel_hi:[1,0,0]
    v_pk_mul_f32 v[48:49], v[48:49], v[134:135]
    v_pk_mul_f32 v[56:57], v[56:57], v[150:151]
    v_pk_mul_f32 v[50:51], v[134:135], v[142:143]
    v_pk_mul_f32 v[58:59], v[150:151], v[158:159]
    v_exp_f32 v48, v48
    v_exp_f32 v49, v49
    v_exp_f32 v56, v56
    v_exp_f32 v57, v57
    v_pk_fma_f32 v[48:49], v[48:49], v[18:19], v[18:19] op_sel_hi:[1,0,0]
    v_pk_fma_f32 v[56:57], v[56:57], v[26:27], v[26:27] op_sel_hi:[1,0,0]
    v_rcp_f32 v48, v48
    v_rcp_f32 v49, v49
    v_rcp_f32 v56, v56
    v_rcp_f32 v57, v57
    v_pk_mul_f32 v[50:51], v[50:51], v[48:49]
    v_pk_mul_f32 v[58:59], v[58:59], v[56:57]
    v_cvt_pk_bf16_f32 v31, v50, v51
    v_cvt_pk_bf16_f32 v163, v58, v59
    s_add_u32 s7, s28, 2
    s_cmp_ge_u32 s7, 86
    s_cbranch_scc1 L_skip_48
    s_add_u32 s7, s7, s32
    s_lshl_b32 s7, s7, 10
    buffer_store_dwordx4 v[28:31], v4, s[20:23], s7 offen sc1
    s_add_u32 s7, s7, 88064
    buffer_store_dwordx4 v[160:163], v4, s[20:23], s7 offen sc1
L_skip_48:
    s_nop 1
L_gpub_42:
    v_mov_b32 v1, 158528
    ds_read_b64 v[164:165], v1
    s_waitcnt vmcnt(0) lgkmcnt(0)
    v_mov_b32 v1, 158536
    v_mov_b32 v2, 1
    s_mov_b64 exec, 1
    ds_add_rtn_u32 v3, v1, v2
    s_mov_b64 exec, -1
    s_waitcnt lgkmcnt(0)
    v_readfirstlane_b32 s7, v3
    s_cmp_lg_u32 s7, 3
    s_cbranch_scc1 L_nfh_49
    s_lshl_b32 s30, s4, 4
    s_add_u32 s30, s30, s5
    s_lshl_b32 s7, s30, 7
    s_add_u32 s7, s7, 19562496
    v_mov_b32 v1, s7
    s_mov_b64 exec, 1
    global_store_dwordx2 v1, v[164:165], s[66:67] sc1
    s_mov_b64 exec, -1
L_nfh_49:
    s_cmp_lg_u32 s3, 0
    s_cbranch_scc1 L_gpe_50
    s_and_b32 s7, s2, 7
    s_lshr_b32 s33, s2, 3
    s_lshr_b32 s34, s7, 1
    s_lshl_b32 s34, s34, 3
    s_and_b32 s35, s33, 7
    s_add_u32 s34, s34, s35
    s_and_b32 s7, s7, 1
    s_lshl_b32 s7, s7, 2
    s_lshr_b32 s35, s33, 3
    s_add_u32 s35, s35, s7
    s_lshr_b32 s7, s34, 1
    s_lshl_b32 s7, s7, 4
    v_min_u32 v2, 14, v0
    v_add_u32 v2, s7, v2
    v_lshlrev_b32 v2, 7, v2
    v_add_u32 v2, 19562496, v2
    s_mov_b32 s99, 0
L_poll_51:
    global_load_dwordx2 v[4:5], v2, s[66:67] sc1
    s_add_u32 s99, s99, 1
    s_waitcnt vmcnt(0)
    v_cmp_ne_u32 vcc, v164, v4
    v_cmp_ne_u32 s[30:31], v165, v5
    s_or_b64 vcc, vcc, s[30:31]
    s_cmp_eq_u64 vcc, 0
    s_cbranch_scc1 L_pok_52
    s_cmp_gt_u32 s99, 200000
    s_cbranch_scc1 L_pok_52
    s_sleep 8
    s_branch L_poll_51
L_pok_52:
    v_mov_b32 v1, 158544
    v_mov_b32 v2, 1
    ds_write_b32 v1, v2
    s_waitcnt lgkmcnt(0)
L_gpe_50:
    s_endpgm
L_gemm2_7:
    s_mov_b32 s80, s68
    s_mov_b32 s12, s60
    s_mov_b32 s13, s61
    s_mov_b32 s14, 1409024
    s_mov_b32 s15, 0x20000
    s_and_b32 s7, s2, 7
    s_lshr_b32 s33, s2, 3
    s_lshr_b32 s78, s7, 1
    s_lshl_b32 s78, s78, 3
    s_and_b32 s79, s33, 7
    s_add_u32 s78, s78, s79
    s_and_b32 s7, s7, 1
    s_lshl_b32 s7, s7, 2
    s_lshr_b32 s79, s33, 3
    s_add_u32 s79, s79, s7
    s_and_b32 s32, s80, 3
    s_lshl_b32 s32, s32, 4
    s_lshl_b32 s33, s78, 6
    s_add_u32 s32, s32, s33
    v_and_b32 v2, 15, v0
    v_add_u32 v2, s32, v2
    v_lshlrev_b32 v2, 10, v2
    s_lshr_b32 s32, s80, 2
    s_lshl_b32 s32, s32, 6
    s_lshl_b32 s33, s79, 7
    s_add_u32 s32, s32, s33
    v_lshrrev_b32 v3, 4, v0
    v_lshlrev_b32 v3, 4, v3
    v_add_u32 v2, v2, v3
    v_add_u32 v166, s32, v2
    s_mov_b32 s81, 22
    s_cmp_ge_u32 s80, 2
    s_cselect_b32 s81, 21, s81
    v_lshlrev_b32 v1, 4, v0
    s_mul_i32 s7, s78, 176128
    s_add_u32 s7, s7, 0
    v_add_u32 v8, s7, v1
    v_add_u32 v9, 88064, v8
    v_lshrrev_b32 v2, 3, v0
    v_lshlrev_b32 v2, 10, v2
    v_and_b32 v3, 7, v0
    v_bfe_u32 v4, v0, 4, 1
    v_lshlrev_b32 v4, 2, v4
    v_xor_b32 v3, v3, v4
    v_lshlrev_b32 v3, 4, v3
    v_add_u32 v10, v2, v3
    s_lshl_b32 s29, s79, 7
    s_mul_i32 s28, s80, 8192
    s_add_u32 s28, s28, 42240
    v_lshrrev_b32 v2, 5, v0
    v_lshlrev_b32 v2, 2, v2
    v_bfe_u32 v3, v0, 2, 2
    v_add_u32 v2, v2, v3
    v_lshlrev_b32 v2, 7, v2
    v_lshrrev_b32 v3, 1, v3
    v_lshlrev_b32 v3, 6, v3
    v_add_u32 v2, v2, v3
    v_bfe_u32 v3, v0, 4, 1
    v_lshlrev_b32 v3, 5, v3
    v_add_u32 v2, v2, v3
    v_and_b32 v3, 3, v0
    v_lshlrev_b32 v3, 3, v3
    v_add_u32 v2, v2, v3
    v_add_u32 v11, s28, v2
    v_xor_b32 v2, 64, v2
    v_add_u32 v13, s28, v2
    v_lshrrev_b32 v2, 3, v0
    s_lshl_b32 s7, s80, 4
    s_lshl_b32 s30, s79, 6
    s_add_u32 s7, s7, s30
    v_add_u32 v2, s7, v2
    v_lshlrev_b32 v2, 12, v2
    v_and_b32 v3, 7, v0
    v_lshlrev_b32 v3, 4, v3
    v_add_u32 v2, v2, v3
    s_lshl_b32 s30, s78, 7
    s_add_u32 s30, s30, 13631488
    v_add_u32 v12, s30, v2
    s_lshr_b32 s7, s7, 1
    v_min_u32 v2, 7, v0
    v_add_u32 v2, s7, v2
    v_lshlrev_b32 v2, 7, v2
    v_add_u32 v14, 19595264, v2
    v_mov_b32 v1, 158528
    ds_read_b64 v[164:165], v1
    s_mov_b32 s8, s66
    s_mov_b32 s9, s67
    s_mov_b32 s10, 19922944
    s_mov_b32 s11, 0x20000
    s_mov_b32 s12, s60
    s_mov_b32 s13, s61
    s_mov_b32 s14, 1409024
    s_mov_b32 s15, 0x20000
    v_mov_b32 v16, 0
    v_mov_b32 v17, 0
    v_mov_b32 v18, 0
    v_mov_b32 v19, 0
    v_mov_b32 v20, 0
    v_mov_b32 v21, 0
    v_mov_b32 v22, 0
    v_mov_b32 v23, 0
    v_mov_b32 v24, 0
    v_mov_b32 v25, 0
    v_mov_b32 v26, 0
    v_mov_b32 v27, 0
    v_mov_b32 v28, 0
    v_mov_b32 v29, 0
    v_mov_b32 v30, 0
    v_mov_b32 v31, 0
    v_mov_b32 v32, 0
    v_mov_b32 v33, 0
    v_mov_b32 v34, 0
    v_mov_b32 v35, 0
    v_mov_b32 v36, 0
    v_mov_b32 v37, 0
    v_mov_b32 v38, 0
    v_mov_b32 v39, 0
    v_mov_b32 v40, 0
    v_mov_b32 v41, 0
    v_mov_b32 v42, 0
    v_mov_b32 v43, 0
    v_mov_b32 v44, 0
    v_mov_b32 v45, 0
    v_mov_b32 v46, 0
    v_mov_b32 v47, 0
    v_mov_b32 v48, 0
    v_mov_b32 v49, 0
    v_mov_b32 v50, 0
    v_mov_b32 v51, 0
    v_mov_b32 v52, 0
    v_mov_b32 v53, 0
    v_mov_b32 v54, 0
    v_mov_b32 v55, 0
    v_mov_b32 v56, 0
    v_mov_b32 v57, 0
    v_mov_b32 v58, 0
    v_mov_b32 v59, 0
    v_mov_b32 v60, 0
    v_mov_b32 v61, 0
    v_mov_b32 v62, 0
    v_mov_b32 v63, 0
    v_mov_b32 v64, 0
    v_mov_b32 v65, 0
    v_mov_b32 v66, 0
    v_mov_b32 v67, 0
    v_mov_b32 v68, 0
    v_mov_b32 v69, 0
    v_mov_b32 v70, 0
    v_mov_b32 v71, 0
    v_mov_b32 v72, 0
    v_mov_b32 v73, 0
    v_mov_b32 v74, 0
    v_mov_b32 v75, 0
    v_mov_b32 v76, 0
    v_mov_b32 v77, 0
    v_mov_b32 v78, 0
    v_mov_b32 v79, 0
    s_waitcnt lgkmcnt(0)
    s_mov_b32 s24, 180
    s_mov_b32 s25, 225
    s_bitcmp1_b32 s79, 0
    s_cselect_b32 s24, s25, s24
    s_mul_i32 s30, s80, 6
    s_lshl_b32 s31, s80, 2
    s_cmp_eq_u32 s80, 3
    s_cselect_b32 s31, 11, s31
    s_cmp_ge_u32 s80, 2
    s_cselect_b32 s32, 3, 4
    s_lshr_b32 s7, s24, 0
    s_and_b32 s7, s7, 3
    s_mul_i32 s33, s7, 24
    s_cmp_eq_u32 s7, 3
    s_cselect_b32 s25, s31, s30
    s_add_u32 s70, s33, s25
    s_cmp_eq_u32 s7, 3
    s_cselect_b32 s74, s32, 6
    s_lshr_b32 s7, s24, 2
    s_and_b32 s7, s7, 3
    s_mul_i32 s33, s7, 24
    s_cmp_eq_u32 s7, 3
    s_cselect_b32 s25, s31, s30
    s_add_u32 s71, s33, s25
    s_cmp_eq_u32 s7, 3
    s_cselect_b32 s75, s32, 6
    s_lshr_b32 s7, s24, 4
    s_and_b32 s7, s7, 3
    s_mul_i32 s33, s7, 24
    s_cmp_eq_u32 s7, 3
    s_cselect_b32 s25, s31, s30
    s_add_u32 s72, s33, s25
    s_cmp_eq_u32 s7, 3
    s_cselect_b32 s76, s32, 6
    s_lshr_b32 s7, s24, 6
    s_and_b32 s7, s7, 3
    s_mul_i32 s33, s7, 24
    s_cmp_eq_u32 s7, 3
    s_cselect_b32 s25, s31, s30
    s_add_u32 s73, s33, s25
    s_cmp_eq_u32 s7, 3
    s_cselect_b32 s77, s32, 6
    s_mov_b32 s85, 0
    s_lshr_b32 s7, s74, 1
    s_bitcmp1_b32 s79, 1
    s_cselect_b32 s94, s7, 0
    s_add_u32 s7, s70, s94
    s_lshl_b32 s82, s7, 14
    s_add_u32 s82, s82, s29
    s_lshl_b32 s83, s7, 10
    s_add_u32 s7, s70, s74
    s_lshl_b32 s88, s7, 10
    s_mov_b32 s84, s74
    v_mov_b32 v1, 158588
    s_mov_b32 s99, 0
L_spinq_53:
    ds_read_b32 v3, v1
    s_add_u32 s99, s99, 1
    s_waitcnt lgkmcnt(0)
    v_readfirstlane_b32 s7, v3
    s_cmp_gt_u32 s99, 1000000
    s_cselect_b32 s7, 4, s7
    s_cmp_lg_u32 s7, 4
    s_cbranch_scc1 L_spinq_53
    s_setprio 1
    s_add_u32 m0, s28, 0
    s_add_u32 s31, s82, 8192
    buffer_load_dwordx4 v10, s[12:15], s82 offen lds
    s_add_u32 m0, s28, 1024
    s_nop 0
    buffer_load_dwordx4 v10, s[12:15], s31 offen lds
    s_mov_b32 s95, s83
    s_add_u32 s82, s82, 16384
    s_add_u32 s83, s83, 1024
    s_cmp_lg_u32 s83, s88
    s_cbranch_scc1 L_nowrap_55
    s_lshl_b32 s7, s74, 14
    s_sub_u32 s82, s82, s7
    s_lshl_b32 s7, s74, 10
    s_sub_u32 s83, s83, s7
L_nowrap_55:
    s_sub_u32 s84, s84, 1
    s_cmp_lg_u32 s84, 0
    s_cbranch_scc1 L_noadv_54
    s_mov_b32 s70, s71
    s_mov_b32 s71, s72
    s_mov_b32 s72, s73
    s_mov_b32 s74, s75
    s_mov_b32 s75, s76
    s_mov_b32 s76, s77
    s_add_u32 s85, s85, 1
    s_lshr_b32 s7, s74, 1
    s_bitcmp1_b32 s79, 1
    s_cselect_b32 s94, s7, 0
    s_add_u32 s7, s70, s94
    s_lshl_b32 s82, s7, 14
    s_add_u32 s82, s82, s29
    s_lshl_b32 s83, s7, 10
    s_add_u32 s7, s70, s74
    s_lshl_b32 s88, s7, 10
    s_mov_b32 s84, s74
L_noadv_54:
    s_add_u32 m0, s28, 2048
    s_add_u32 s31, s82, 8192
    buffer_load_dwordx4 v10, s[12:15], s82 offen lds
    s_add_u32 m0, s28, 3072
    s_nop 0
    buffer_load_dwordx4 v10, s[12:15], s31 offen lds
    s_mov_b32 s96, s83
    s_add_u32 s82, s82, 16384
    s_add_u32 s83, s83, 1024
    s_cmp_lg_u32 s83, s88
    s_cbranch_scc1 L_nowrap_57
    s_lshl_b32 s7, s74, 14
    s_sub_u32 s82, s82, s7
    s_lshl_b32 s7, s74, 10
    s_sub_u32 s83, s83, s7
L_nowrap_57:
    s_sub_u32 s84, s84, 1
    s_cmp_lg_u32 s84, 0
    s_cbranch_scc1 L_noadv_56
    s_mov_b32 s70, s71
    s_mov_b32 s71, s72
    s_mov_b32 s72, s73
    s_mov_b32 s74, s75
    s_mov_b32 s75, s76
    s_mov_b32 s76, s77
    s_add_u32 s85, s85, 1
    s_lshr_b32 s7, s74, 1
    s_bitcmp1_b32 s79, 1
    s_cselect_b32 s94, s7, 0
    s_add_u32 s7, s70, s94
    s_lshl_b32 s82, s7, 14
    s_add_u32 s82, s82, s29
    s_lshl_b32 s83, s7, 10
    s_add_u32 s7, s70, s74
    s_lshl_b32 s88, s7, 10
    s_mov_b32 s84, s74
L_noadv_56:
    s_add_u32 m0, s28, 4096
    s_add_u32 s31, s82, 8192
    buffer_load_dwordx4 v10, s[12:15], s82 offen lds
    s_add_u32 m0, s28, 5120
    s_nop 0
    buffer_load_dwordx4 v10, s[12:15], s31 offen lds
    s_mov_b32 s97, s83
    s_add_u32 s82, s82, 16384
    s_add_u32 s83, s83, 1024
    s_cmp_lg_u32 s83, s88
    s_cbranch_scc1 L_nowrap_59
    s_lshl_b32 s7, s74, 14
    s_sub_u32 s82, s82, s7
    s_lshl_b32 s7, s74, 10
    s_sub_u32 s83, s83, s7
L_nowrap_59:
    s_sub_u32 s84, s84, 1
    s_cmp_lg_u32 s84, 0
    s_cbranch_scc1 L_noadv_58
    s_mov_b32 s70, s71
    s_mov_b32 s71, s72
    s_mov_b32 s72, s73
    s_mov_b32 s74, s75
    s_mov_b32 s75, s76
    s_mov_b32 s76, s77
    s_add_u32 s85, s85, 1
    s_lshr_b32 s7, s74, 1
    s_bitcmp1_b32 s79, 1
    s_cselect_b32 s94, s7, 0
    s_add_u32 s7, s70, s94
    s_lshl_b32 s82, s7, 14
    s_add_u32 s82, s82, s29
    s_lshl_b32 s83, s7, 10
    s_add_u32 s7, s70, s74
    s_lshl_b32 s88, s7, 10
    s_mov_b32 s84, s74
L_noadv_58:
    s_add_u32 m0, s28, 6144
    s_add_u32 s31, s82, 8192
    buffer_load_dwordx4 v10, s[12:15], s82 offen lds
    s_add_u32 m0, s28, 7168
    s_nop 0
    buffer_load_dwordx4 v10, s[12:15], s31 offen lds
    s_mov_b32 s98, s83
    s_add_u32 s82, s82, 16384
    s_add_u32 s83, s83, 1024
    s_cmp_lg_u32 s83, s88
    s_cbranch_scc1 L_nowrap_61
    s_lshl_b32 s7, s74, 14
    s_sub_u32 s82, s82, s7
    s_lshl_b32 s7, s74, 10
    s_sub_u32 s83, s83, s7
L_nowrap_61:
    s_sub_u32 s84, s84, 1
    s_cmp_lg_u32 s84, 0
    s_cbranch_scc1 L_noadv_60
    s_mov_b32 s70, s71
    s_mov_b32 s71, s72
    s_mov_b32 s72, s73
    s_mov_b32 s74, s75
    s_mov_b32 s75, s76
    s_mov_b32 s76, s77
    s_add_u32 s85, s85, 1
    s_lshr_b32 s7, s74, 1
    s_bitcmp1_b32 s79, 1
    s_cselect_b32 s94, s7, 0
    s_add_u32 s7, s70, s94
    s_lshl_b32 s82, s7, 14
    s_add_u32 s82, s82, s29
    s_lshl_b32 s83, s7, 10
    s_add_u32 s7, s70, s74
    s_lshl_b32 s88, s7, 10
    s_mov_b32 s84, s74
L_noadv_60:
    s_cmp_lg_u32 s80, 0
    s_cbranch_scc1 L_hoth_62
    v_mov_b32 v1, 158536
    s_mov_b32 s99, 0
L_spinq_66:
    ds_read_b32 v3, v1
    s_add_u32 s99, s99, 1
    s_waitcnt lgkmcnt(0)
    v_readfirstlane_b32 s7, v3
    s_cmp_gt_u32 s99, 1000000
    s_cselect_b32 s7, 4, s7
    s_cmp_lg_u32 s7, 4
    s_cbranch_scc1 L_spinq_66
    v_min_u32 v2, 7, v0
    s_lshr_b32 s7, s78, 1
    s_lshl_b32 s7, s7, 4
    v_add_u32 v2, s7, v2
    v_lshlrev_b32 v2, 7, v2
    v_add_u32 v2, 19562496, v2
    s_mov_b32 s99, 0
L_poll_67:
    global_load_dwordx2 v[4:5], v2, s[66:67] sc1
    s_add_u32 s99, s99, 1
    s_waitcnt vmcnt(0)
    v_cmp_ne_u32 vcc, v164, v4
    v_cmp_ne_u32 s[30:31], v165, v5
    s_or_b64 vcc, vcc, s[30:31]
    s_cmp_eq_u64 vcc, 0
    s_cbranch_scc1 L_pok_68
    s_cmp_gt_u32 s99, 200000
    s_cbranch_scc1 L_pok_68
    s_sleep 2
    s_branch L_poll_67
L_pok_68:
    v_mov_b32 v1, 158580
    v_mov_b32 v2, 1
    ds_write_b32 v1, v2
    s_branch L_hgo_63
L_hoth_62:
    v_mov_b32 v1, 158580
    s_mov_b32 s99, 0
L_spin_69:
    ds_read_b32 v3, v1
    s_add_u32 s99, s99, 1
    s_waitcnt lgkmcnt(0)
    v_readfirstlane_b32 s24, v3
    s_cmp_gt_u32 s99, 1000000
    s_cselect_b32 s24, 1, s24
    s_cmp_eq_u32 s24, 0
    s_cbranch_scc1 L_spin_69
L_hgo_63:
    s_waitcnt vmcnt(0)
    buffer_load_dwordx4 v[80:83], v8, s[8:11], s95 offen sc1
    buffer_load_dwordx4 v[84:87], v9, s[8:11], s95 offen sc1
    buffer_load_dwordx4 v[88:91], v8, s[8:11], s96 offen sc1
    buffer_load_dwordx4 v[92:95], v9, s[8:11], s96 offen sc1
    buffer_load_dwordx4 v[96:99], v8, s[8:11], s97 offen sc1
    buffer_load_dwordx4 v[100:103], v9, s[8:11], s97 offen sc1
    buffer_load_dwordx4 v[104:107], v8, s[8:11], s98 offen sc1
    buffer_load_dwordx4 v[108:111], v9, s[8:11], s98 offen sc1
    s_waitcnt vmcnt(6)
    ds_read_b64_tr_b16 v[112:113], v11 offset:0
    ds_read_b64_tr_b16 v[114:115], v11 offset:1024
    ds_read_b64_tr_b16 v[116:117], v13 offset:0
    ds_read_b64_tr_b16 v[118:119], v13 offset:1024
    s_waitcnt vmcnt(4) lgkmcnt(0)
    ds_read_b64_tr_b16 v[120:121], v11 offset:2048
    ds_read_b64_tr_b16 v[122:123], v11 offset:3072
    ds_read_b64_tr_b16 v[124:125], v13 offset:2048
    ds_read_b64_tr_b16 v[126:127], v13 offset:3072
    v_mfma_f32_32x32x16_bf16 v[16:31], v[112:115], v[80:83], v[16:31]
    s_add_u32 m0, s28, 0
    s_add_u32 s31, s82, 8192
    buffer_load_dwordx4 v10, s[12:15], s82 offen lds
    v_mfma_f32_32x32x16_bf16 v[48:63], v[116:119], v[80:83], v[48:63]
    buffer_load_dwordx4 v[80:83], v8, s[8:11], s83 offen sc1
    v_mfma_f32_32x32x16_bf16 v[32:47], v[112:115], v[84:87], v[32:47]
    s_add_u32 m0, s28, 1024
    s_nop 0
    buffer_load_dwordx4 v10, s[12:15], s31 offen lds
    v_mfma_f32_32x32x16_bf16 v[64:79], v[116:119], v[84:87], v[64:79]
    buffer_load_dwordx4 v[84:87], v9, s[8:11], s83 offen sc1
    s_add_u32 s82, s82, 16384
    s_add_u32 s83, s83, 1024
    s_cmp_lg_u32 s83, s88
    s_cbranch_scc1 L_nowrap_72
    s_lshl_b32 s7, s74, 14
    s_sub_u32 s82, s82, s7
    s_lshl_b32 s7, s74, 10
    s_sub_u32 s83, s83, s7
L_nowrap_72:
    s_sub_u32 s84, s84, 1
    s_cmp_lg_u32 s84, 0
    s_cbranch_scc1 L_noadv_71
    s_mov_b32 s70, s71
    s_mov_b32 s71, s72
    s_mov_b32 s72, s73
    s_mov_b32 s74, s75
    s_mov_b32 s75, s76
    s_mov_b32 s76, s77
    s_add_u32 s85, s85, 1
    s_lshr_b32 s7, s74, 1
    s_bitcmp1_b32 s79, 1
    s_cselect_b32 s94, s7, 0
    s_add_u32 s7, s70, s94
    s_lshl_b32 s82, s7, 14
    s_add_u32 s82, s82, s29
    s_lshl_b32 s83, s7, 10
    s_add_u32 s7, s70, s74
    s_lshl_b32 s88, s7, 10
    s_mov_b32 s84, s74
L_noadv_71:
    s_waitcnt vmcnt(6) lgkmcnt(0)
    ds_read_b64_tr_b16 v[112:113], v11 offset:4096
    ds_read_b64_tr_b16 v[114:115], v11 offset:5120
    ds_read_b64_tr_b16 v[116:117], v13 offset:4096
    ds_read_b64_tr_b16 v[118:119], v13 offset:5120
    v_mfma_f32_32x32x16_bf16 v[16:31], v[120:123], v[88:91], v[16:31]
    s_add_u32 m0, s28, 2048
    s_add_u32 s31, s82, 8192
    buffer_load_dwordx4 v10, s[12:15], s82 offen lds
    v_mfma_f32_32x32x16_bf16 v[48:63], v[124:127], v[88:91], v[48:63]
    buffer_load_dwordx4 v[88:91], v8, s[8:11], s83 offen sc1
    v_mfma_f32_32x32x16_bf16 v[32:47], v[120:123], v[92:95], v[32:47]
    s_add_u32 m0, s28, 3072
    s_nop 0
    buffer_load_dwordx4 v10, s[12:15], s31 offen lds
    v_mfma_f32_32x32x16_bf16 v[64:79], v[124:127], v[92:95], v[64:79]
    buffer_load_dwordx4 v[92:95], v9, s[8:11], s83 offen sc1
    s_add_u32 s82, s82, 16384
    s_add_u32 s83, s83, 1024
    s_cmp_lg_u32 s83, s88
    s_cbranch_scc1 L_nowrap_74
    s_lshl_b32 s7, s74, 14
    s_sub_u32 s82, s82, s7
    s_lshl_b32 s7, s74, 10
    s_sub_u32 s83, s83, s7
L_nowrap_74:
    s_sub_u32 s84, s84, 1
    s_cmp_lg_u32 s84, 0
    s_cbranch_scc1 L_noadv_73
    s_mov_b32 s70, s71
    s_mov_b32 s71, s72
    s_mov_b32 s72, s73
    s_mov_b32 s74, s75
    s_mov_b32 s75, s76
    s_mov_b32 s76, s77
    s_add_u32 s85, s85, 1
    s_lshr_b32 s7, s74, 1
    s_bitcmp1_b32 s79, 1
    s_cselect_b32 s94, s7, 0
    s_add_u32 s7, s70, s94
    s_lshl_b32 s82, s7, 14
    s_add_u32 s82, s82, s29
    s_lshl_b32 s83, s7, 10
    s_add_u32 s7, s70, s74
    s_lshl_b32 s88, s7, 10
    s_mov_b32 s84, s74
L_noadv_73:
    s_waitcnt vmcnt(8) lgkmcnt(0)
    ds_read_b64_tr_b16 v[120:121], v11 offset:6144
    ds_read_b64_tr_b16 v[122:123], v11 offset:7168
    ds_read_b64_tr_b16 v[124:125], v13 offset:6144
    ds_read_b64_tr_b16 v[126:127], v13 offset:7168
    v_mfma_f32_32x32x16_bf16 v[16:31], v[112:115], v[96:99], v[16:31]
    s_add_u32 m0, s28, 4096
    s_add_u32 s31, s82, 8192
    buffer_load_dwordx4 v10, s[12:15], s82 offen lds
    v_mfma_f32_32x32x16_bf16 v[48:63], v[116:119], v[96:99], v[48:63]
    buffer_load_dwordx4 v[96:99], v8, s[8:11], s83 offen sc1
    v_mfma_f32_32x32x16_bf16 v[32:47], v[112:115], v[100:103], v[32:47]
    s_add_u32 m0, s28, 5120
    s_nop 0
    buffer_load_dwordx4 v10, s[12:15], s31 offen lds
    v_mfma_f32_32x32x16_bf16 v[64:79], v[116:119], v[100:103], v[64:79]
    buffer_load_dwordx4 v[100:103], v9, s[8:11], s83 offen sc1
    s_add_u32 s82, s82, 16384
    s_add_u32 s83, s83, 1024
    s_cmp_lg_u32 s83, s88
    s_cbranch_scc1 L_nowrap_76
    s_lshl_b32 s7, s74, 14
    s_sub_u32 s82, s82, s7
    s_lshl_b32 s7, s74, 10
    s_sub_u32 s83, s83, s7
L_nowrap_76:
    s_sub_u32 s84, s84, 1
    s_cmp_lg_u32 s84, 0
    s_cbranch_scc1 L_noadv_75
    s_mov_b32 s70, s71
    s_mov_b32 s71, s72
    s_mov_b32 s72, s73
    s_mov_b32 s74, s75
    s_mov_b32 s75, s76
    s_mov_b32 s76, s77
    s_add_u32 s85, s85, 1
    s_lshr_b32 s7, s74, 1
    s_bitcmp1_b32 s79, 1
    s_cselect_b32 s94, s7, 0
    s_add_u32 s7, s70, s94
    s_lshl_b32 s82, s7, 14
    s_add_u32 s82, s82, s29
    s_lshl_b32 s83, s7, 10
    s_add_u32 s7, s70, s74
    s_lshl_b32 s88, s7, 10
    s_mov_b32 s84, s74
L_noadv_75:
    s_waitcnt vmcnt(8) lgkmcnt(0)
    ds_read_b64_tr_b16 v[112:113], v11 offset:0
    ds_read_b64_tr_b16 v[114:115], v11 offset:1024
    ds_read_b64_tr_b16 v[116:117], v13 offset:0
    ds_read_b64_tr_b16 v[118:119], v13 offset:1024
    v_mfma_f32_32x32x16_bf16 v[16:31], v[120:123], v[104:107], v[16:31]
    s_add_u32 m0, s28, 6144
    s_add_u32 s31, s82, 8192
    buffer_load_dwordx4 v10, s[12:15], s82 offen lds
    v_mfma_f32_32x32x16_bf16 v[48:63], v[124:127], v[104:107], v[48:63]
    buffer_load_dwordx4 v[104:107], v8, s[8:11], s83 offen sc1
    v_mfma_f32_32x32x16_bf16 v[32:47], v[120:123], v[108:111], v[32:47]
    s_add_u32 m0, s28, 7168
    s_nop 0
    buffer_load_dwordx4 v10, s[12:15], s31 offen lds
    v_mfma_f32_32x32x16_bf16 v[64:79], v[124:127], v[108:111], v[64:79]
    buffer_load_dwordx4 v[108:111], v9, s[8:11], s83 offen sc1
    s_add_u32 s82, s82, 16384
    s_add_u32 s83, s83, 1024
    s_cmp_lg_u32 s83, s88
    s_cbranch_scc1 L_nowrap_78
    s_lshl_b32 s7, s74, 14
    s_sub_u32 s82, s82, s7
    s_lshl_b32 s7, s74, 10
    s_sub_u32 s83, s83, s7
L_nowrap_78:
    s_sub_u32 s84, s84, 1
    s_cmp_lg_u32 s84, 0
    s_cbranch_scc1 L_noadv_77
    s_mov_b32 s70, s71
    s_mov_b32 s71, s72
    s_mov_b32 s72, s73
    s_mov_b32 s74, s75
    s_mov_b32 s75, s76
    s_mov_b32 s76, s77
    s_add_u32 s85, s85, 1
    s_lshr_b32 s7, s74, 1
    s_bitcmp1_b32 s79, 1
    s_cselect_b32 s94, s7, 0
    s_add_u32 s7, s70, s94
    s_lshl_b32 s82, s7, 14
    s_add_u32 s82, s82, s29
    s_lshl_b32 s83, s7, 10
    s_add_u32 s7, s70, s74
    s_lshl_b32 s88, s7, 10
    s_mov_b32 s84, s74
L_noadv_77:
    s_waitcnt vmcnt(8) lgkmcnt(0)
    ds_read_b64_tr_b16 v[120:121], v11 offset:2048
    ds_read_b64_tr_b16 v[122:123], v11 offset:3072
    ds_read_b64_tr_b16 v[124:125], v13 offset:2048
    ds_read_b64_tr_b16 v[126:127], v13 offset:3072
    v_mfma_f32_32x32x16_bf16 v[16:31], v[112:115], v[80:83], v[16:31]
    s_add_u32 m0, s28, 0
    s_add_u32 s31, s82, 8192
    buffer_load_dwordx4 v10, s[12:15], s82 offen lds
    v_mfma_f32_32x32x16_bf16 v[48:63], v[116:119], v[80:83], v[48:63]
    buffer_load_dwordx4 v[80:83], v8, s[8:11], s83 offen sc1
    v_mfma_f32_32x32x16_bf16 v[32:47], v[112:115], v[84:87], v[32:47]
    s_add_u32 m0, s28, 1024
    s_nop 0
    buffer_load_dwordx4 v10, s[12:15], s31 offen lds
    v_mfma_f32_32x32x16_bf16 v[64:79], v[116:119], v[84:87], v[64:79]
    buffer_load_dwordx4 v[84:87], v9, s[8:11], s83 offen sc1
    s_add_u32 s82, s82, 16384
    s_add_u32 s83, s83, 1024
    s_cmp_lg_u32 s83, s88
    s_cbranch_scc1 L_nowrap_80
    s_lshl_b32 s7, s74, 14
    s_sub_u32 s82, s82, s7
    s_lshl_b32 s7, s74, 10
    s_sub_u32 s83, s83, s7
L_nowrap_80:
    s_sub_u32 s84, s84, 1
    s_cmp_lg_u32 s84, 0
    s_cbranch_scc1 L_noadv_79
    s_mov_b32 s70, s71
    s_mov_b32 s71, s72
    s_mov_b32 s72, s73
    s_mov_b32 s74, s75
    s_mov_b32 s75, s76
    s_mov_b32 s76, s77
    s_add_u32 s85, s85, 1
    s_lshr_b32 s7, s74, 1
    s_bitcmp1_b32 s79, 1
    s_cselect_b32 s94, s7, 0
    s_add_u32 s7, s70, s94
    s_lshl_b32 s82, s7, 14
    s_add_u32 s82, s82, s29
    s_lshl_b32 s83, s7, 10
    s_add_u32 s7, s70, s74
    s_lshl_b32 s88, s7, 10
    s_mov_b32 s84, s74
    s_cmp_lg_u32 s85, 2
    s_cbranch_scc1 L_noadv_79
    v_mov_b32 v1, 158544
    s_mov_b32 s99, 0
L_spin_81:
    ds_read_b32 v3, v1
    s_add_u32 s99, s99, 1
    s_waitcnt lgkmcnt(0)
    v_readfirstlane_b32 s24, v3
    s_cmp_gt_u32 s99, 1000000
    s_cselect_b32 s24, 1, s24
    s_cmp_eq_u32 s24, 0
    s_cbranch_scc1 L_spin_81
L_noadv_79:
    s_waitcnt vmcnt(8) lgkmcnt(0)
    ds_read_b64_tr_b16 v[112:113], v11 offset:4096
    ds_read_b64_tr_b16 v[114:115], v11 offset:5120
    ds_read_b64_tr_b16 v[116:117], v13 offset:4096
    ds_read_b64_tr_b16 v[118:119], v13 offset:5120
    v_mfma_f32_32x32x16_bf16 v[16:31], v[120:123], v[88:91], v[16:31]
    s_add_u32 m0, s28, 2048
    s_add_u32 s31, s82, 8192
    buffer_load_dwordx4 v10, s[12:15], s82 offen lds
    v_mfma_f32_32x32x16_bf16 v[48:63], v[124:127], v[88:91], v[48:63]
    buffer_load_dwordx4 v[88:91], v8, s[8:11], s83 offen sc1
    v_mfma_f32_32x32x16_bf16 v[32:47], v[120:123], v[92:95], v[32:47]
    s_add_u32 m0, s28, 3072
    s_nop 0
    buffer_load_dwordx4 v10, s[12:15], s31 offen lds
    v_mfma_f32_32x32x16_bf16 v[64:79], v[124:127], v[92:95], v[64:79]
    buffer_load_dwordx4 v[92:95], v9, s[8:11], s83 offen sc1
    s_add_u32 s82, s82, 16384
    s_add_u32 s83, s83, 1024
    s_cmp_lg_u32 s83, s88
    s_cbranch_scc1 L_nowrap_83
    s_lshl_b32 s7, s74, 14
    s_sub_u32 s82, s82, s7
    s_lshl_b32 s7, s74, 10
    s_sub_u32 s83, s83, s7
L_nowrap_83:
    s_sub_u32 s84, s84, 1
    s_cmp_lg_u32 s84, 0
    s_cbranch_scc1 L_noadv_82
    s_mov_b32 s70, s71
    s_mov_b32 s71, s72
    s_mov_b32 s72, s73
    s_mov_b32 s74, s75
    s_mov_b32 s75, s76
    s_mov_b32 s76, s77
    s_add_u32 s85, s85, 1
    s_lshr_b32 s7, s74, 1
    s_bitcmp1_b32 s79, 1
    s_cselect_b32 s94, s7, 0
    s_add_u32 s7, s70, s94
    s_lshl_b32 s82, s7, 14
    s_add_u32 s82, s82, s29
    s_lshl_b32 s83, s7, 10
    s_add_u32 s7, s70, s74
    s_lshl_b32 s88, s7, 10
    s_mov_b32 s84, s74
    s_cmp_lg_u32 s85, 2
    s_cbranch_scc1 L_noadv_82
    v_mov_b32 v1, 158544
    s_mov_b32 s99, 0
L_spin_84:
    ds_read_b32 v3, v1
    s_add_u32 s99, s99, 1
    s_waitcnt lgkmcnt(0)
    v_readfirstlane_b32 s24, v3
    s_cmp_gt_u32 s99, 1000000
    s_cselect_b32 s24, 1, s24
    s_cmp_eq_u32 s24, 0
    s_cbranch_scc1 L_spin_84
L_noadv_82:
    s_waitcnt vmcnt(8) lgkmcnt(0)
    ds_read_b64_tr_b16 v[120:121], v11 offset:6144
    ds_read_b64_tr_b16 v[122:123], v11 offset:7168
    ds_read_b64_tr_b16 v[124:125], v13 offset:6144
    ds_read_b64_tr_b16 v[126:127], v13 offset:7168
    v_mfma_f32_32x32x16_bf16 v[16:31], v[112:115], v[96:99], v[16:31]
    s_add_u32 m0, s28, 4096
    s_add_u32 s31, s82, 8192
    buffer_load_dwordx4 v10, s[12:15], s82 offen lds
    v_mfma_f32_32x32x16_bf16 v[48:63], v[116:119], v[96:99], v[48:63]
    buffer_load_dwordx4 v[96:99], v8, s[8:11], s83 offen sc1
    v_mfma_f32_32x32x16_bf16 v[32:47], v[112:115], v[100:103], v[32:47]
    s_add_u32 m0, s28, 5120
    s_nop 0
    buffer_load_dwordx4 v10, s[12:15], s31 offen lds
    v_mfma_f32_32x32x16_bf16 v[64:79], v[116:119], v[100:103], v[64:79]
    buffer_load_dwordx4 v[100:103], v9, s[8:11], s83 offen sc1
    s_add_u32 s82, s82, 16384
    s_add_u32 s83, s83, 1024
    s_cmp_lg_u32 s83, s88
    s_cbranch_scc1 L_nowrap_86
    s_lshl_b32 s7, s74, 14
    s_sub_u32 s82, s82, s7
    s_lshl_b32 s7, s74, 10
    s_sub_u32 s83, s83, s7
L_nowrap_86:
    s_sub_u32 s84, s84, 1
    s_cmp_lg_u32 s84, 0
    s_cbranch_scc1 L_noadv_85
    s_mov_b32 s70, s71
    s_mov_b32 s71, s72
    s_mov_b32 s72, s73
    s_mov_b32 s74, s75
    s_mov_b32 s75, s76
    s_mov_b32 s76, s77
    s_add_u32 s85, s85, 1
    s_lshr_b32 s7, s74, 1
    s_bitcmp1_b32 s79, 1
    s_cselect_b32 s94, s7, 0
    s_add_u32 s7, s70, s94
    s_lshl_b32 s82, s7, 14
    s_add_u32 s82, s82, s29
    s_lshl_b32 s83, s7, 10
    s_add_u32 s7, s70, s74
    s_lshl_b32 s88, s7, 10
    s_mov_b32 s84, s74
L_noadv_85:
    s_waitcnt vmcnt(8) lgkmcnt(0)
    ds_read_b64_tr_b16 v[112:113], v11 offset:0
    ds_read_b64_tr_b16 v[114:115], v11 offset:1024
    ds_read_b64_tr_b16 v[116:117], v13 offset:0
    ds_read_b64_tr_b16 v[118:119], v13 offset:1024
    v_mfma_f32_32x32x16_bf16 v[16:31], v[120:123], v[104:107], v[16:31]
    s_add_u32 m0, s28, 6144
    s_add_u32 s31, s82, 8192
    buffer_load_dwordx4 v10, s[12:15], s82 offen lds
    v_mfma_f32_32x32x16_bf16 v[48:63], v[124:127], v[104:107], v[48:63]
    buffer_load_dwordx4 v[104:107], v8, s[8:11], s83 offen sc1
    v_mfma_f32_32x32x16_bf16 v[32:47], v[120:123], v[108:111], v[32:47]
    s_add_u32 m0, s28, 7168
    s_nop 0
    buffer_load_dwordx4 v10, s[12:15], s31 offen lds
    v_mfma_f32_32x32x16_bf16 v[64:79], v[124:127], v[108:111], v[64:79]
    buffer_load_dwordx4 v[108:111], v9, s[8:11], s83 offen sc1
    s_add_u32 s82, s82, 16384
    s_add_u32 s83, s83, 1024
    s_cmp_lg_u32 s83, s88
    s_cbranch_scc1 L_nowrap_88
    s_lshl_b32 s7, s74, 14
    s_sub_u32 s82, s82, s7
    s_lshl_b32 s7, s74, 10
    s_sub_u32 s83, s83, s7
L_nowrap_88:
    s_sub_u32 s84, s84, 1
    s_cmp_lg_u32 s84, 0
    s_cbranch_scc1 L_noadv_87
    s_mov_b32 s70, s71
    s_mov_b32 s71, s72
    s_mov_b32 s72, s73
    s_mov_b32 s74, s75
    s_mov_b32 s75, s76
    s_mov_b32 s76, s77
    s_add_u32 s85, s85, 1
    s_lshr_b32 s7, s74, 1
    s_bitcmp1_b32 s79, 1
    s_cselect_b32 s94, s7, 0
    s_add_u32 s7, s70, s94
    s_lshl_b32 s82, s7, 14
    s_add_u32 s82, s82, s29
    s_lshl_b32 s83, s7, 10
    s_add_u32 s7, s70, s74
    s_lshl_b32 s88, s7, 10
    s_mov_b32 s84, s74
    s_cmp_lg_u32 s85, 2
    s_cbranch_scc1 L_noadv_87
    v_mov_b32 v1, 158544
    s_mov_b32 s99, 0
L_spin_89:
    ds_read_b32 v3, v1
    s_add_u32 s99, s99, 1
    s_waitcnt lgkmcnt(0)
    v_readfirstlane_b32 s24, v3
    s_cmp_gt_u32 s99, 1000000
    s_cselect_b32 s24, 1, s24
    s_cmp_eq_u32 s24, 0
    s_cbranch_scc1 L_spin_89
L_noadv_87:
    s_waitcnt vmcnt(8) lgkmcnt(0)
    ds_read_b64_tr_b16 v[120:121], v11 offset:2048
    ds_read_b64_tr_b16 v[122:123], v11 offset:3072
    ds_read_b64_tr_b16 v[124:125], v13 offset:2048
    ds_read_b64_tr_b16 v[126:127], v13 offset:3072
    v_mfma_f32_32x32x16_bf16 v[16:31], v[112:115], v[80:83], v[16:31]
    s_add_u32 m0, s28, 0
    s_add_u32 s31, s82, 8192
    buffer_load_dwordx4 v10, s[12:15], s82 offen lds
    v_mfma_f32_32x32x16_bf16 v[48:63], v[116:119], v[80:83], v[48:63]
    buffer_load_dwordx4 v[80:83], v8, s[8:11], s83 offen sc1
    v_mfma_f32_32x32x16_bf16 v[32:47], v[112:115], v[84:87], v[32:47]
    s_add_u32 m0, s28, 1024
    s_nop 0
    buffer_load_dwordx4 v10, s[12:15], s31 offen lds
    v_mfma_f32_32x32x16_bf16 v[64:79], v[116:119], v[84:87], v[64:79]
    buffer_load_dwordx4 v[84:87], v9, s[8:11], s83 offen sc1
    s_add_u32 s82, s82, 16384
    s_add_u32 s83, s83, 1024
    s_cmp_lg_u32 s83, s88
    s_cbranch_scc1 L_nowrap_91
    s_lshl_b32 s7, s74, 14
    s_sub_u32 s82, s82, s7
    s_lshl_b32 s7, s74, 10
    s_sub_u32 s83, s83, s7
L_nowrap_91:
    s_sub_u32 s84, s84, 1
    s_cmp_lg_u32 s84, 0
    s_cbranch_scc1 L_noadv_90
    s_mov_b32 s70, s71
    s_mov_b32 s71, s72
    s_mov_b32 s72, s73
    s_mov_b32 s74, s75
    s_mov_b32 s75, s76
    s_mov_b32 s76, s77
    s_add_u32 s85, s85, 1
    s_lshr_b32 s7, s74, 1
    s_bitcmp1_b32 s79, 1
    s_cselect_b32 s94, s7, 0
    s_add_u32 s7, s70, s94
    s_lshl_b32 s82, s7, 14
    s_add_u32 s82, s82, s29
    s_lshl_b32 s83, s7, 10
    s_add_u32 s7, s70, s74
    s_lshl_b32 s88, s7, 10
    s_mov_b32 s84, s74
L_noadv_90:
    s_waitcnt vmcnt(8) lgkmcnt(0)
    ds_read_b64_tr_b16 v[112:113], v11 offset:4096
    ds_read_b64_tr_b16 v[114:115], v11 offset:5120
    ds_read_b64_tr_b16 v[116:117], v13 offset:4096
    ds_read_b64_tr_b16 v[118:119], v13 offset:5120
    v_mfma_f32_32x32x16_bf16 v[16:31], v[120:123], v[88:91], v[16:31]
    s_add_u32 m0, s28, 2048
    s_add_u32 s31, s82, 8192
    buffer_load_dwordx4 v10, s[12:15], s82 offen lds
    v_mfma_f32_32x32x16_bf16 v[48:63], v[124:127], v[88:91], v[48:63]
    buffer_load_dwordx4 v[88:91], v8, s[8:11], s83 offen sc1
    v_mfma_f32_32x32x16_bf16 v[32:47], v[120:123], v[92:95], v[32:47]
    s_add_u32 m0, s28, 3072
    s_nop 0
    buffer_load_dwordx4 v10, s[12:15], s31 offen lds
    v_mfma_f32_32x32x16_bf16 v[64:79], v[124:127], v[92:95], v[64:79]
    buffer_load_dwordx4 v[92:95], v9, s[8:11], s83 offen sc1
    s_add_u32 s82, s82, 16384
    s_add_u32 s83, s83, 1024
    s_cmp_lg_u32 s83, s88
    s_cbranch_scc1 L_nowrap_93
    s_lshl_b32 s7, s74, 14
    s_sub_u32 s82, s82, s7
    s_lshl_b32 s7, s74, 10
    s_sub_u32 s83, s83, s7
L_nowrap_93:
    s_sub_u32 s84, s84, 1
    s_cmp_lg_u32 s84, 0
    s_cbranch_scc1 L_noadv_92
    s_mov_b32 s70, s71
    s_mov_b32 s71, s72
    s_mov_b32 s72, s73
    s_mov_b32 s74, s75
    s_mov_b32 s75, s76
    s_mov_b32 s76, s77
    s_add_u32 s85, s85, 1
    s_lshr_b32 s7, s74, 1
    s_bitcmp1_b32 s79, 1
    s_cselect_b32 s94, s7, 0
    s_add_u32 s7, s70, s94
    s_lshl_b32 s82, s7, 14
    s_add_u32 s82, s82, s29
    s_lshl_b32 s83, s7, 10
    s_add_u32 s7, s70, s74
    s_lshl_b32 s88, s7, 10
    s_mov_b32 s84, s74
L_noadv_92:
    s_waitcnt vmcnt(8) lgkmcnt(0)
    ds_read_b64_tr_b16 v[120:121], v11 offset:6144
    ds_read_b64_tr_b16 v[122:123], v11 offset:7168
    ds_read_b64_tr_b16 v[124:125], v13 offset:6144
    ds_read_b64_tr_b16 v[126:127], v13 offset:7168
    v_mfma_f32_32x32x16_bf16 v[16:31], v[112:115], v[96:99], v[16:31]
    s_add_u32 m0, s28, 4096
    s_add_u32 s31, s82, 8192
    buffer_load_dwordx4 v10, s[12:15], s82 offen lds
    v_mfma_f32_32x32x16_bf16 v[48:63], v[116:119], v[96:99], v[48:63]
    buffer_load_dwordx4 v[96:99], v8, s[8:11], s83 offen sc1
    v_mfma_f32_32x32x16_bf16 v[32:47], v[112:115], v[100:103], v[32:47]
    s_add_u32 m0, s28, 5120
    s_nop 0
    buffer_load_dwordx4 v10, s[12:15], s31 offen lds
    v_mfma_f32_32x32x16_bf16 v[64:79], v[116:119], v[100:103], v[64:79]
    buffer_load_dwordx4 v[100:103], v9, s[8:11], s83 offen sc1
    s_add_u32 s82, s82, 16384
    s_add_u32 s83, s83, 1024
    s_cmp_lg_u32 s83, s88
    s_cbranch_scc1 L_nowrap_95
    s_lshl_b32 s7, s74, 14
    s_sub_u32 s82, s82, s7
    s_lshl_b32 s7, s74, 10
    s_sub_u32 s83, s83, s7
L_nowrap_95:
    s_sub_u32 s84, s84, 1
    s_cmp_lg_u32 s84, 0
    s_cbranch_scc1 L_noadv_94
    s_mov_b32 s70, s71
    s_mov_b32 s71, s72
    s_mov_b32 s72, s73
    s_mov_b32 s74, s75
    s_mov_b32 s75, s76
    s_mov_b32 s76, s77
    s_add_u32 s85, s85, 1
    s_lshr_b32 s7, s74, 1
    s_bitcmp1_b32 s79, 1
    s_cselect_b32 s94, s7, 0
    s_add_u32 s7, s70, s94
    s_lshl_b32 s82, s7, 14
    s_add_u32 s82, s82, s29
    s_lshl_b32 s83, s7, 10
    s_add_u32 s7, s70, s74
    s_lshl_b32 s88, s7, 10
    s_mov_b32 s84, s74
L_noadv_94:
    s_waitcnt vmcnt(8) lgkmcnt(0)
    ds_read_b64_tr_b16 v[112:113], v11 offset:0
    ds_read_b64_tr_b16 v[114:115], v11 offset:1024
    ds_read_b64_tr_b16 v[116:117], v13 offset:0
    ds_read_b64_tr_b16 v[118:119], v13 offset:1024
    v_mfma_f32_32x32x16_bf16 v[16:31], v[120:123], v[104:107], v[16:31]
    s_add_u32 m0, s28, 6144
    s_add_u32 s31, s82, 8192
    buffer_load_dwordx4 v10, s[12:15], s82 offen lds
    v_mfma_f32_32x32x16_bf16 v[48:63], v[124:127], v[104:107], v[48:63]
    buffer_load_dwordx4 v[104:107], v8, s[8:11], s83 offen sc1
    v_mfma_f32_32x32x16_bf16 v[32:47], v[120:123], v[108:111], v[32:47]
    s_add_u32 m0, s28, 7168
    s_nop 0
    buffer_load_dwordx4 v10, s[12:15], s31 offen lds
    v_mfma_f32_32x32x16_bf16 v[64:79], v[124:127], v[108:111], v[64:79]
    buffer_load_dwordx4 v[108:111], v9, s[8:11], s83 offen sc1
    s_add_u32 s82, s82, 16384
    s_add_u32 s83, s83, 1024
    s_cmp_lg_u32 s83, s88
    s_cbranch_scc1 L_nowrap_97
    s_lshl_b32 s7, s74, 14
    s_sub_u32 s82, s82, s7
    s_lshl_b32 s7, s74, 10
    s_sub_u32 s83, s83, s7
L_nowrap_97:
    s_sub_u32 s84, s84, 1
    s_cmp_lg_u32 s84, 0
    s_cbranch_scc1 L_noadv_96
    s_mov_b32 s70, s71
    s_mov_b32 s71, s72
    s_mov_b32 s72, s73
    s_mov_b32 s74, s75
    s_mov_b32 s75, s76
    s_mov_b32 s76, s77
    s_add_u32 s85, s85, 1
    s_lshr_b32 s7, s74, 1
    s_bitcmp1_b32 s79, 1
    s_cselect_b32 s94, s7, 0
    s_add_u32 s7, s70, s94
    s_lshl_b32 s82, s7, 14
    s_add_u32 s82, s82, s29
    s_lshl_b32 s83, s7, 10
    s_add_u32 s7, s70, s74
    s_lshl_b32 s88, s7, 10
    s_mov_b32 s84, s74
L_noadv_96:
    s_waitcnt vmcnt(8) lgkmcnt(0)
    ds_read_b64_tr_b16 v[120:121], v11 offset:2048
    ds_read_b64_tr_b16 v[122:123], v11 offset:3072
    ds_read_b64_tr_b16 v[124:125], v13 offset:2048
    ds_read_b64_tr_b16 v[126:127], v13 offset:3072
    v_mfma_f32_32x32x16_bf16 v[16:31], v[112:115], v[80:83], v[16:31]
    s_add_u32 m0, s28, 0
    s_add_u32 s31, s82, 8192
    buffer_load_dwordx4 v10, s[12:15], s82 offen lds
    v_mfma_f32_32x32x16_bf16 v[48:63], v[116:119], v[80:83], v[48:63]
    buffer_load_dwordx4 v[80:83], v8, s[8:11], s83 offen sc1
    v_mfma_f32_32x32x16_bf16 v[32:47], v[112:115], v[84:87], v[32:47]
    s_add_u32 m0, s28, 1024
    s_nop 0
    buffer_load_dwordx4 v10, s[12:15], s31 offen lds
    v_mfma_f32_32x32x16_bf16 v[64:79], v[116:119], v[84:87], v[64:79]
    buffer_load_dwordx4 v[84:87], v9, s[8:11], s83 offen sc1
    s_add_u32 s82, s82, 16384
    s_add_u32 s83, s83, 1024
    s_cmp_lg_u32 s83, s88
    s_cbranch_scc1 L_nowrap_99
    s_lshl_b32 s7, s74, 14
    s_sub_u32 s82, s82, s7
    s_lshl_b32 s7, s74, 10
    s_sub_u32 s83, s83, s7
L_nowrap_99:
    s_sub_u32 s84, s84, 1
    s_cmp_lg_u32 s84, 0
    s_cbranch_scc1 L_noadv_98
    s_mov_b32 s70, s71
    s_mov_b32 s71, s72
    s_mov_b32 s72, s73
    s_mov_b32 s74, s75
    s_mov_b32 s75, s76
    s_mov_b32 s76, s77
    s_add_u32 s85, s85, 1
    s_lshr_b32 s7, s74, 1
    s_bitcmp1_b32 s79, 1
    s_cselect_b32 s94, s7, 0
    s_add_u32 s7, s70, s94
    s_lshl_b32 s82, s7, 14
    s_add_u32 s82, s82, s29
    s_lshl_b32 s83, s7, 10
    s_add_u32 s7, s70, s74
    s_lshl_b32 s88, s7, 10
    s_mov_b32 s84, s74
L_noadv_98:
    s_waitcnt vmcnt(8) lgkmcnt(0)
    ds_read_b64_tr_b16 v[112:113], v11 offset:4096
    ds_read_b64_tr_b16 v[114:115], v11 offset:5120
    ds_read_b64_tr_b16 v[116:117], v13 offset:4096
    ds_read_b64_tr_b16 v[118:119], v13 offset:5120
    v_mfma_f32_32x32x16_bf16 v[16:31], v[120:123], v[88:91], v[16:31]
    s_add_u32 m0, s28, 2048
    s_add_u32 s31, s82, 8192
    buffer_load_dwordx4 v10, s[12:15], s82 offen lds
    v_mfma_f32_32x32x16_bf16 v[48:63], v[124:127], v[88:91], v[48:63]
    buffer_load_dwordx4 v[88:91], v8, s[8:11], s83 offen sc1
    v_mfma_f32_32x32x16_bf16 v[32:47], v[120:123], v[92:95], v[32:47]
    s_add_u32 m0, s28, 3072
    s_nop 0
    buffer_load_dwordx4 v10, s[12:15], s31 offen lds
    v_mfma_f32_32x32x16_bf16 v[64:79], v[124:127], v[92:95], v[64:79]
    buffer_load_dwordx4 v[92:95], v9, s[8:11], s83 offen sc1
    s_add_u32 s82, s82, 16384
    s_add_u32 s83, s83, 1024
    s_cmp_lg_u32 s83, s88
    s_cbranch_scc1 L_nowrap_101
    s_lshl_b32 s7, s74, 14
    s_sub_u32 s82, s82, s7
    s_lshl_b32 s7, s74, 10
    s_sub_u32 s83, s83, s7
L_nowrap_101:
    s_sub_u32 s84, s84, 1
    s_cmp_lg_u32 s84, 0
    s_cbranch_scc1 L_noadv_100
    s_mov_b32 s70, s71
    s_mov_b32 s71, s72
    s_mov_b32 s72, s73
    s_mov_b32 s74, s75
    s_mov_b32 s75, s76
    s_mov_b32 s76, s77
    s_add_u32 s85, s85, 1
    s_lshr_b32 s7, s74, 1
    s_bitcmp1_b32 s79, 1
    s_cselect_b32 s94, s7, 0
    s_add_u32 s7, s70, s94
    s_lshl_b32 s82, s7, 14
    s_add_u32 s82, s82, s29
    s_lshl_b32 s83, s7, 10
    s_add_u32 s7, s70, s74
    s_lshl_b32 s88, s7, 10
    s_mov_b32 s84, s74
L_noadv_100:
    s_waitcnt vmcnt(8) lgkmcnt(0)
    ds_read_b64_tr_b16 v[120:121], v11 offset:6144
    ds_read_b64_tr_b16 v[122:123], v11 offset:7168
    ds_read_b64_tr_b16 v[124:125], v13 offset:6144
    ds_read_b64_tr_b16 v[126:127], v13 offset:7168
    v_mfma_f32_32x32x16_bf16 v[16:31], v[112:115], v[96:99], v[16:31]
    s_add_u32 m0, s28, 4096
    s_add_u32 s31, s82, 8192
    buffer_load_dwordx4 v10, s[12:15], s82 offen lds
    v_mfma_f32_32x32x16_bf16 v[48:63], v[116:119], v[96:99], v[48:63]
    buffer_load_dwordx4 v[96:99], v8, s[8:11], s83 offen sc1
    v_mfma_f32_32x32x16_bf16 v[32:47], v[112:115], v[100:103], v[32:47]
    s_add_u32 m0, s28, 5120
    s_nop 0
    buffer_load_dwordx4 v10, s[12:15], s31 offen lds
    v_mfma_f32_32x32x16_bf16 v[64:79], v[116:119], v[100:103], v[64:79]
    buffer_load_dwordx4 v[100:103], v9, s[8:11], s83 offen sc1
    s_add_u32 s82, s82, 16384
    s_add_u32 s83, s83, 1024
    s_cmp_lg_u32 s83, s88
    s_cbranch_scc1 L_nowrap_103
    s_lshl_b32 s7, s74, 14
    s_sub_u32 s82, s82, s7
    s_lshl_b32 s7, s74, 10
    s_sub_u32 s83, s83, s7
L_nowrap_103:
    s_sub_u32 s84, s84, 1
    s_cmp_lg_u32 s84, 0
    s_cbranch_scc1 L_noadv_102
    s_mov_b32 s70, s71
    s_mov_b32 s71, s72
    s_mov_b32 s72, s73
    s_mov_b32 s74, s75
    s_mov_b32 s75, s76
    s_mov_b32 s76, s77
    s_add_u32 s85, s85, 1
    s_lshr_b32 s7, s74, 1
    s_bitcmp1_b32 s79, 1
    s_cselect_b32 s94, s7, 0
    s_add_u32 s7, s70, s94
    s_lshl_b32 s82, s7, 14
    s_add_u32 s82, s82, s29
    s_lshl_b32 s83, s7, 10
    s_add_u32 s7, s70, s74
    s_lshl_b32 s88, s7, 10
    s_mov_b32 s84, s74
L_noadv_102:
    s_waitcnt vmcnt(8) lgkmcnt(0)
    ds_read_b64_tr_b16 v[112:113], v11 offset:0
    ds_read_b64_tr_b16 v[114:115], v11 offset:1024
    ds_read_b64_tr_b16 v[116:117], v13 offset:0
    ds_read_b64_tr_b16 v[118:119], v13 offset:1024
    v_mfma_f32_32x32x16_bf16 v[16:31], v[120:123], v[104:107], v[16:31]
    s_add_u32 m0, s28, 6144
    s_add_u32 s31, s82, 8192
    buffer_load_dwordx4 v10, s[12:15], s82 offen lds
    v_mfma_f32_32x32x16_bf16 v[48:63], v[124:127], v[104:107], v[48:63]
    buffer_load_dwordx4 v[104:107], v8, s[8:11], s83 offen sc1
    v_mfma_f32_32x32x16_bf16 v[32:47], v[120:123], v[108:111], v[32:47]
    s_add_u32 m0, s28, 7168
    s_nop 0
    buffer_load_dwordx4 v10, s[12:15], s31 offen lds
    v_mfma_f32_32x32x16_bf16 v[64:79], v[124:127], v[108:111], v[64:79]
    buffer_load_dwordx4 v[108:111], v9, s[8:11], s83 offen sc1
    s_add_u32 s82, s82, 16384
    s_add_u32 s83, s83, 1024
    s_cmp_lg_u32 s83, s88
    s_cbranch_scc1 L_nowrap_105
    s_lshl_b32 s7, s74, 14
    s_sub_u32 s82, s82, s7
    s_lshl_b32 s7, s74, 10
    s_sub_u32 s83, s83, s7
L_nowrap_105:
    s_sub_u32 s84, s84, 1
    s_cmp_lg_u32 s84, 0
    s_cbranch_scc1 L_noadv_104
    s_mov_b32 s70, s71
    s_mov_b32 s71, s72
    s_mov_b32 s72, s73
    s_mov_b32 s74, s75
    s_mov_b32 s75, s76
    s_mov_b32 s76, s77
    s_add_u32 s85, s85, 1
    s_lshr_b32 s7, s74, 1
    s_bitcmp1_b32 s79, 1
    s_cselect_b32 s94, s7, 0
    s_add_u32 s7, s70, s94
    s_lshl_b32 s82, s7, 14
    s_add_u32 s82, s82, s29
    s_lshl_b32 s83, s7, 10
    s_add_u32 s7, s70, s74
    s_lshl_b32 s88, s7, 10
    s_mov_b32 s84, s74
L_noadv_104:
    s_waitcnt vmcnt(8) lgkmcnt(0)
    ds_read_b64_tr_b16 v[120:121], v11 offset:2048
    ds_read_b64_tr_b16 v[122:123], v11 offset:3072
    ds_read_b64_tr_b16 v[124:125], v13 offset:2048
    ds_read_b64_tr_b16 v[126:127], v13 offset:3072
    v_mfma_f32_32x32x16_bf16 v[16:31], v[112:115], v[80:83], v[16:31]
    s_add_u32 m0, s28, 0
    s_add_u32 s31, s82, 8192
    buffer_load_dwordx4 v10, s[12:15], s82 offen lds
    v_mfma_f32_32x32x16_bf16 v[48:63], v[116:119], v[80:83], v[48:63]
    buffer_load_dwordx4 v[80:83], v8, s[8:11], s83 offen sc1
    v_mfma_f32_32x32x16_bf16 v[32:47], v[112:115], v[84:87], v[32:47]
    s_add_u32 m0, s28, 1024
    s_nop 0
    buffer_load_dwordx4 v10, s[12:15], s31 offen lds
    v_mfma_f32_32x32x16_bf16 v[64:79], v[116:119], v[84:87], v[64:79]
    buffer_load_dwordx4 v[84:87], v9, s[8:11], s83 offen sc1
    s_add_u32 s82, s82, 16384
    s_add_u32 s83, s83, 1024
    s_cmp_lg_u32 s83, s88
    s_cbranch_scc1 L_nowrap_107
    s_lshl_b32 s7, s74, 14
    s_sub_u32 s82, s82, s7
    s_lshl_b32 s7, s74, 10
    s_sub_u32 s83, s83, s7
L_nowrap_107:
    s_sub_u32 s84, s84, 1
    s_cmp_lg_u32 s84, 0
    s_cbranch_scc1 L_noadv_106
    s_mov_b32 s70, s71
    s_mov_b32 s71, s72
    s_mov_b32 s72, s73
    s_mov_b32 s74, s75
    s_mov_b32 s75, s76
    s_mov_b32 s76, s77
    s_add_u32 s85, s85, 1
    s_lshr_b32 s7, s74, 1
    s_bitcmp1_b32 s79, 1
    s_cselect_b32 s94, s7, 0
    s_add_u32 s7, s70, s94
    s_lshl_b32 s82, s7, 14
    s_add_u32 s82, s82, s29
    s_lshl_b32 s83, s7, 10
    s_add_u32 s7, s70, s74
    s_lshl_b32 s88, s7, 10
    s_mov_b32 s84, s74
L_noadv_106:
    s_waitcnt vmcnt(8) lgkmcnt(0)
    ds_read_b64_tr_b16 v[112:113], v11 offset:4096
    ds_read_b64_tr_b16 v[114:115], v11 offset:5120
    ds_read_b64_tr_b16 v[116:117], v13 offset:4096
    ds_read_b64_tr_b16 v[118:119], v13 offset:5120
    v_mfma_f32_32x32x16_bf16 v[16:31], v[120:123], v[88:91], v[16:31]
    s_add_u32 m0, s28, 2048
    s_add_u32 s31, s82, 8192
    buffer_load_dwordx4 v10, s[12:15], s82 offen lds
    v_mfma_f32_32x32x16_bf16 v[48:63], v[124:127], v[88:91], v[48:63]
    buffer_load_dwordx4 v[88:91], v8, s[8:11], s83 offen sc1
    v_mfma_f32_32x32x16_bf16 v[32:47], v[120:123], v[92:95], v[32:47]
    s_add_u32 m0, s28, 3072
    s_nop 0
    buffer_load_dwordx4 v10, s[12:15], s31 offen lds
    v_mfma_f32_32x32x16_bf16 v[64:79], v[124:127], v[92:95], v[64:79]
    buffer_load_dwordx4 v[92:95], v9, s[8:11], s83 offen sc1
    s_add_u32 s82, s82, 16384
    s_add_u32 s83, s83, 1024
    s_cmp_lg_u32 s83, s88
    s_cbranch_scc1 L_nowrap_109
    s_lshl_b32 s7, s74, 14
    s_sub_u32 s82, s82, s7
    s_lshl_b32 s7, s74, 10
    s_sub_u32 s83, s83, s7
L_nowrap_109:
    s_sub_u32 s84, s84, 1
    s_cmp_lg_u32 s84, 0
    s_cbranch_scc1 L_noadv_108
    s_mov_b32 s70, s71
    s_mov_b32 s71, s72
    s_mov_b32 s72, s73
    s_mov_b32 s74, s75
    s_mov_b32 s75, s76
    s_mov_b32 s76, s77
    s_add_u32 s85, s85, 1
    s_lshr_b32 s7, s74, 1
    s_bitcmp1_b32 s79, 1
    s_cselect_b32 s94, s7, 0
    s_add_u32 s7, s70, s94
    s_lshl_b32 s82, s7, 14
    s_add_u32 s82, s82, s29
    s_lshl_b32 s83, s7, 10
    s_add_u32 s7, s70, s74
    s_lshl_b32 s88, s7, 10
    s_mov_b32 s84, s74
L_noadv_108:
    global_load_dwordx2 v[142:143], v14, s[66:67] sc1
    s_waitcnt vmcnt(9) lgkmcnt(0)
    ds_read_b64_tr_b16 v[120:121], v11 offset:6144
    ds_read_b64_tr_b16 v[122:123], v11 offset:7168
    ds_read_b64_tr_b16 v[124:125], v13 offset:6144
    ds_read_b64_tr_b16 v[126:127], v13 offset:7168
    v_mfma_f32_32x32x16_bf16 v[16:31], v[112:115], v[96:99], v[16:31]
    v_mfma_f32_32x32x16_bf16 v[48:63], v[116:119], v[96:99], v[48:63]
    v_mfma_f32_32x32x16_bf16 v[32:47], v[112:115], v[100:103], v[32:47]
    v_mfma_f32_32x32x16_bf16 v[64:79], v[116:119], v[100:103], v[64:79]
    s_waitcnt vmcnt(5) lgkmcnt(0)
    ds_read_b64_tr_b16 v[112:113], v11 offset:0
    ds_read_b64_tr_b16 v[114:115], v11 offset:1024
    ds_read_b64_tr_b16 v[116:117], v13 offset:0
    ds_read_b64_tr_b16 v[118:119], v13 offset:1024
    v_mfma_f32_32x32x16_bf16 v[16:31], v[120:123], v[104:107], v[16:31]
    v_mfma_f32_32x32x16_bf16 v[48:63], v[124:127], v[104:107], v[48:63]
    v_mfma_f32_32x32x16_bf16 v[32:47], v[120:123], v[108:111], v[32:47]
    v_mfma_f32_32x32x16_bf16 v[64:79], v[124:127], v[108:111], v[64:79]
    s_waitcnt vmcnt(1) lgkmcnt(0)
    ds_read_b64_tr_b16 v[120:121], v11 offset:2048
    ds_read_b64_tr_b16 v[122:123], v11 offset:3072
    ds_read_b64_tr_b16 v[124:125], v13 offset:2048
    ds_read_b64_tr_b16 v[126:127], v13 offset:3072
    v_mfma_f32_32x32x16_bf16 v[16:31], v[112:115], v[80:83], v[16:31]
    v_mfma_f32_32x32x16_bf16 v[48:63], v[116:119], v[80:83], v[48:63]
    v_mfma_f32_32x32x16_bf16 v[32:47], v[112:115], v[84:87], v[32:47]
    v_mfma_f32_32x32x16_bf16 v[64:79], v[116:119], v[84:87], v[64:79]
    s_waitcnt vmcnt(0)
    v_cmp_ne_u32 vcc, v164, v142
    v_cmp_ne_u32 s[30:31], v165, v143
    s_or_b64 vcc, vcc, s[30:31]
    s_cmp_eq_u64 vcc, 0
    s_cbranch_scc1 L_yfok_110
    s_mov_b32 s99, 0
L_poll_111:
    global_load_dwordx2 v[142:143], v14, s[66:67] sc1
    s_add_u32 s99, s99, 1
    s_waitcnt vmcnt(0)
    v_cmp_ne_u32 vcc, v164, v142
    v_cmp_ne_u32 s[30:31], v165, v143
    s_or_b64 vcc, vcc, s[30:31]
    s_cmp_eq_u64 vcc, 0
    s_cbranch_scc1 L_pok_112
    s_cmp_gt_u32 s99, 200000
    s_cbranch_scc1 L_pok_112
    s_sleep 1
    s_branch L_poll_111
L_pok_112:
L_yfok_110:
    global_load_dwordx4 v[160:163], v166, s[36:37]
    buffer_load_dwordx4 v[128:131], v12, s[8:11], 0 offen sc1
    s_mov_b32 s27, 32768
    buffer_load_dwordx4 v[132:135], v12, s[8:11], s27 offen sc1
    s_cmp_eq_u32 s81, 21
    s_cbranch_scc1 L_gskip_70
    s_waitcnt lgkmcnt(0)
    v_mfma_f32_32x32x16_bf16 v[16:31], v[120:123], v[88:91], v[16:31]
    v_mfma_f32_32x32x16_bf16 v[48:63], v[124:127], v[88:91], v[48:63]
    v_mfma_f32_32x32x16_bf16 v[32:47], v[120:123], v[92:95], v[32:47]
    v_mfma_f32_32x32x16_bf16 v[64:79], v[124:127], v[92:95], v[64:79]
L_gskip_70:
    v_and_b32 v1, 31, v0
    v_mul_u32_u24 v1, 272, v1
    v_lshrrev_b32 v2, 5, v0
    v_lshlrev_b32 v2, 4, v2
    v_add_u32 v1, v1, v2
    s_mul_i32 s7, s80, 17408
    s_add_u32 s7, s7, 85248
    v_add_u32 v1, s7, v1
    v_lshrrev_b32 v2, 3, v0
    s_lshl_b32 s7, s80, 4
    v_add_u32 v2, s7, v2
    v_mul_u32_u24 v2, 160, v2
    v_and_b32 v3, 7, v0
    v_lshlrev_b32 v3, 4, v3
    v_add_u32 v2, v2, v3
    v_add_u32 v2, 75008, v2
    ds_write_b128 v1, v[16:19] offset:0
    ds_write_b128 v1, v[20:23] offset:32
    ds_write_b128 v1, v[24:27] offset:64
    ds_write_b128 v1, v[28:31] offset:96
    ds_write_b128 v1, v[32:35] offset:8704
    ds_write_b128 v1, v[36:39] offset:8736
    ds_write_b128 v1, v[40:43] offset:8768
    ds_write_b128 v1, v[44:47] offset:8800
    ds_write_b128 v1, v[48:51] offset:128
    ds_write_b128 v1, v[52:55] offset:160
    ds_write_b128 v1, v[56:59] offset:192
    ds_write_b128 v1, v[60:63] offset:224
    ds_write_b128 v1, v[64:67] offset:8832
    ds_write_b128 v1, v[68:71] offset:8864
    ds_write_b128 v1, v[72:75] offset:8896
    ds_write_b128 v1, v[76:79] offset:8928
    s_waitcnt vmcnt(0)
    ds_write_b128 v2, v[128:131] offset:0
    ds_write_b128 v2, v[132:135] offset:1280
    s_branch L_final_1
L_final_1:
    s_mov_b32 s16, s62
    s_mov_b32 s17, s63
    s_mov_b32 s18, 2097152
    s_mov_b32 s19, 0x20000
    s_and_b32 s7, s80, 3
    s_lshl_b32 s7, s7, 4
    v_and_b32 v1, 15, v0
    v_add_u32 v2, s7, v1
    v_mul_u32_u24 v2, 272, v2
    s_lshr_b32 s24, s80, 2
    s_lshl_b32 s24, s24, 2
    v_lshrrev_b32 v3, 4, v0
    v_add_u32 v3, s24, v3
    v_lshlrev_b32 v4, 5, v3
    v_add_u32 v2, v2, v4
    v_add_u32 v2, 85248, v2
    v_lshlrev_b32 v4, 3, v3
    v_lshrrev_b32 v5, 2, v1
    v_add_u32 v4, v4, v5
    v_mul_u32_u24 v4, 160, v4
    v_and_b32 v5, 3, v1
    v_lshlrev_b32 v5, 3, v5
    v_add_u32 v4, v4, v5
    s_lshl_b32 s7, s7, 1
    s_add_u32 s7, s7, 75008
    v_add_u32 v4, s7, v4
    s_waitcnt lgkmcnt(0)
    s_barrier
    ds_read_b128 v[16:19], v2 offset:0
    ds_read_b128 v[20:23], v2 offset:16
    ds_read_b128 v[24:27], v2 offset:17408
    ds_read_b128 v[28:31], v2 offset:17424
    ds_read_b128 v[32:35], v2 offset:34816
    ds_read_b128 v[36:39], v2 offset:34832
    ds_read_b128 v[40:43], v2 offset:52224
    ds_read_b128 v[44:47], v2 offset:52240
    ds_read_b64_tr_b16 v[8:9], v4
    ds_read_b64_tr_b16 v[10:11], v4 offset:640
    v_lshlrev_b32 v56, 16, v160
    v_and_b32 v57, 0xffff0000, v160
    v_lshlrev_b32 v58, 16, v161
    v_and_b32 v59, 0xffff0000, v161
    v_lshlrev_b32 v60, 16, v162
    v_and_b32 v61, 0xffff0000, v162
    v_lshlrev_b32 v62, 16, v163
    v_and_b32 v63, 0xffff0000, v163
    s_waitcnt lgkmcnt(6)
    v_add_f32 v16, v16, v24
    v_add_f32 v17, v17, v25
    v_add_f32 v18, v18, v26
    v_add_f32 v19, v19, v27
    v_add_f32 v20, v20, v28
    v_add_f32 v21, v21, v29
    v_add_f32 v22, v22, v30
    v_add_f32 v23, v23, v31
    s_waitcnt lgkmcnt(2)
    v_add_f32 v32, v32, v40
    v_add_f32 v33, v33, v41
    v_add_f32 v34, v34, v42
    v_add_f32 v35, v35, v43
    v_add_f32 v36, v36, v44
    v_add_f32 v37, v37, v45
    v_add_f32 v38, v38, v46
    v_add_f32 v39, v39, v47
    v_add_f32 v16, v16, v32
    v_add_f32 v17, v17, v33
    v_add_f32 v18, v18, v34
    v_add_f32 v19, v19, v35
    v_add_f32 v20, v20, v36
    v_add_f32 v21, v21, v37
    v_add_f32 v22, v22, v38
    v_add_f32 v23, v23, v39
    v_cvt_pk_bf16_f32 v48, v16, v17
    v_cvt_pk_bf16_f32 v49, v18, v19
    v_cvt_pk_bf16_f32 v50, v20, v21
    v_cvt_pk_bf16_f32 v51, v22, v23
    s_waitcnt lgkmcnt(0)
    v_lshlrev_b32 v64, 16, v8
    v_and_b32 v65, 0xffff0000, v8
    v_lshlrev_b32 v66, 16, v9
    v_and_b32 v67, 0xffff0000, v9
    v_lshlrev_b32 v68, 16, v10
    v_and_b32 v69, 0xffff0000, v10
    v_lshlrev_b32 v70, 16, v11
    v_and_b32 v71, 0xffff0000, v11
    v_add_f32 v56, v56, v64
    v_add_f32 v57, v57, v65
    v_add_f32 v58, v58, v66
    v_add_f32 v59, v59, v67
    v_add_f32 v60, v60, v68
    v_add_f32 v61, v61, v69
    v_add_f32 v62, v62, v70
    v_add_f32 v63, v63, v71
    v_cvt_pk_bf16_f32 v72, v56, v57
    v_cvt_pk_bf16_f32 v73, v58, v59
    v_cvt_pk_bf16_f32 v74, v60, v61
    v_cvt_pk_bf16_f32 v75, v62, v63
    v_lshlrev_b32 v56, 16, v72
    v_and_b32 v57, 0xffff0000, v72
    v_lshlrev_b32 v64, 16, v48
    v_and_b32 v65, 0xffff0000, v48
    v_lshlrev_b32 v58, 16, v73
    v_and_b32 v59, 0xffff0000, v73
    v_lshlrev_b32 v66, 16, v49
    v_and_b32 v67, 0xffff0000, v49
    v_lshlrev_b32 v60, 16, v74
    v_and_b32 v61, 0xffff0000, v74
    v_lshlrev_b32 v68, 16, v50
    v_and_b32 v69, 0xffff0000, v50
    v_lshlrev_b32 v62, 16, v75
    v_and_b32 v63, 0xffff0000, v75
    v_lshlrev_b32 v70, 16, v51
    v_and_b32 v71, 0xffff0000, v51
    v_add_f32 v56, v56, v64
    v_add_f32 v57, v57, v65
    v_add_f32 v58, v58, v66
    v_add_f32 v59, v59, v67
    v_add_f32 v60, v60, v68
    v_add_f32 v61, v61, v69
    v_add_f32 v62, v62, v70
    v_add_f32 v63, v63, v71
    v_cvt_pk_bf16_f32 v76, v56, v57
    v_cvt_pk_bf16_f32 v77, v58, v59
    v_cvt_pk_bf16_f32 v78, v60, v61
    v_cvt_pk_bf16_f32 v79, v62, v63
    buffer_store_dwordx4 v[76:79], v166, s[16:19], 0 offen
    s_endpgm
L_endF_2:
    s_endpgm
.fill 3072, 4, 0xbf800000
.section .rodata,"a"
.p2align 6
.amdhsa_kernel parallel_sum__ssm_conv_s4__geglu_ffn__prompt_kernel
.amdhsa_next_free_vgpr 168
.amdhsa_next_free_sgpr 102
.amdhsa_accum_offset 168
.amdhsa_group_segment_fixed_size 0
.amdhsa_kernarg_size 128
.amdhsa_user_sgpr_count 2
.amdhsa_user_sgpr_kernarg_segment_ptr 1
.amdhsa_system_sgpr_workgroup_id_x 1
.end_amdhsa_kernel
.text
```
